```python
import torch

def _softmax(x, axis=-1):
    return torch.softmax(x, dim=axis)
def _gelu(x):
    return torch.nn.functional.gelu(x, approximate="tanh")
def _silu(x):
    return torch.nn.functional.silu(x)
def _sigmoid(x):
    return torch.sigmoid(x)
def _layernorm(x, axis=-1, eps=1e-5):
    m = x.mean(dim=axis, keepdim=True)
    v = x.var(dim=axis, keepdim=True, unbiased=False)
    return (x - m) / torch.sqrt(v + eps)
def _scatter_add(tgt, idx, src, axis=0):
    return tgt.clone().index_add_(axis, idx, src)
def _segment_sum(src, seg, n):
    out = torch.zeros((n,) + src.shape[1:], dtype=src.dtype)
    return out.index_add_(0, seg, src)
def _pad(x, pw):
    flat = tuple(v for pair in reversed(pw) for v in pair)
    return torch.nn.functional.pad(x, flat)

kernel_name = 'concat_heads__grouped_kv_mqa__compressed_kv_cla__prompt'

def setup_inputs():

    _w = (lambda a: (lambda t: t.to(torch.bfloat16) if t.is_floating_point() else t)(torch.as_tensor(a)))
    def _A_setup():
        B, S, D, H = 1, 2048, 512, 32
        Dh = D // H
        return {
            "x": _w((lambda *s: torch.randn(*s, dtype=torch.bfloat16) * 0.05)(B, S, D)),
            "wq": _w((lambda *s: torch.randn(*s, dtype=torch.bfloat16) * 0.8)(D, H * Dh)),
            "wk": _w((lambda *s: torch.randn(*s, dtype=torch.bfloat16) * 0.8)(D, Dh)),
            "wv": _w((lambda *s: torch.randn(*s, dtype=torch.bfloat16) * 0.05)(D, Dh)),
            "wo": _w((lambda *s: torch.randn(*s, dtype=torch.bfloat16) * 0.05)(H * Dh, D)),
        }
    _A_in = _A_setup()

    def _B_setup():
        B, H, Sq, Sk, D, M = 1, 32, 2048, 2048, 128, 512
        Dc = 4 * D
        return {
            "x": _w((lambda *s: torch.randn(*s, dtype=torch.bfloat16) * 3.2)(B, Sq, M)),
            "c_kv": _w((lambda *s: torch.randn(*s, dtype=torch.bfloat16) * 0.1)(B, Sk, Dc)),
            "w_q": _w((lambda *s: torch.randn(*s, dtype=torch.bfloat16) * 6.4)(M, H, D) * (M ** -0.5)),
            "w_uk": _w((lambda *s: torch.randn(*s, dtype=torch.bfloat16) * 6.4)(Dc, H, D) * (Dc ** -0.5)),
            "w_uv": _w((lambda *s: torch.randn(*s, dtype=torch.bfloat16) * 0.1)(Dc, H, D) * (Dc ** -0.5)),
            "w_o": _w((lambda *s: torch.randn(*s, dtype=torch.bfloat16) * 0.1)(H, D, M) * ((H * D) ** -0.5)),
        }
    _B_in = _B_setup()

    return {
        "A_x": _A_in["x"],
        "A_wq": _A_in["wq"],
        "A_wk": _A_in["wk"],
        "A_wv": _A_in["wv"],
        "A_wo": _A_in["wo"],
        "B_x": _B_in["x"],
        "B_c_kv": _B_in["c_kv"],
        "B_w_q": _B_in["w_q"],
        "B_w_uk": _B_in["w_uk"],
        "B_w_uv": _B_in["w_uv"],
        "B_w_o": _B_in["w_o"],
    }

def reference(A_x, A_wq, A_wk, A_wv, A_wo, B_x, B_c_kv, B_w_q, B_w_uk, B_w_uv, B_w_o):
    def _A_ref(x, wq, wk, wv, wo):
        B, S, D = x.shape
        H = 32
        Dh = D // H
        q = (lambda x, *d: x.permute(*d))((x @ wq).reshape(B, S, H, Dh), 0, 2, 1, 3)
        k = x @ wk
        v = x @ wv
        scores = torch.einsum("bhqd,bkd->bhqk", q, k) * (Dh ** -0.5)
        p = _softmax(scores, axis=-1)
        o = torch.einsum("bhqk,bkd->bhqd", p, v)
        return (lambda x, *d: x.permute(*d))(o, 0, 2, 1, 3).reshape(B, S, H * Dh) @ wo

    def _B_ref(x, c_kv, w_q, w_uk, w_uv, w_o):
        B, Sq, M = x.shape[0], x.shape[1], x.shape[2]
        Sk = c_kv.shape[1]
        H, D = w_q.shape[1], w_q.shape[2]
        q = torch.einsum("bqm,mhd->bhqd", x, w_q)
        k = torch.einsum("bkc,chd->bhkd", c_kv, w_uk)
        v = torch.einsum("bkc,chd->bhkd", c_kv, w_uv)
        scores = torch.einsum("bhqd,bhkd->bhqk", q, k) * (D ** -0.5)
        off = Sk - Sq
        qi = torch.arange(Sq)[:, None]
        kj = torch.arange(Sk)[None, :]
        cmask = kj <= (qi + off)
        scores = torch.where(cmask[None, None], scores, -1e9)
        p = _softmax(scores, axis=-1)
        ctx = torch.einsum("bhqk,bhkd->bhqd", p, v)
        return torch.einsum("bhqd,hdm->bqm", ctx, w_o)

    a = _A_ref(A_x, A_wq, A_wk, A_wv, A_wo)
    b = _B_ref(B_x, B_c_kv, B_w_q, B_w_uk, B_w_uv, B_w_o)
    return torch.concatenate([a, b], axis=-1)
```

```asm
; @launch kernel=proj_kernel grid=(1632,1,1) block=(256,1,1) lds=65536
; @launch kernel=attnb_kernel grid=(768,1,1) block=(256,1,1) lds=65536
; @launch kernel=oproj_kernel grid=(512,1,1) block=(256,1,1) lds=65536
.amdgcn_target "amdgcn-amd-amdhsa--gfx950"
.text
.globl proj_kernel
.p2align 8
.type proj_kernel,@function
proj_kernel:
    s_cmp_ge_u32 s2, 1632
    s_cbranch_scc1 proj_exit
    s_load_dwordx16 s[36:51], s[0:1], 0
    s_load_dwordx8 s[52:59], s[0:1], 64
    s_load_dwordx4 s[60:63], s[0:1], 96
    v_lshrrev_b32 v1, 6, v0
    v_and_b32 v0, 63, v0
    s_nop 0
    v_readfirstlane_b32 s16, v1
    s_waitcnt lgkmcnt(0)
    s_and_b32 s17, s16, 1
    s_lshr_b32 s18, s16, 1
    s_and_b32 s30, s2, 511
    s_and_b32 s31, s30, 31
    s_lshr_b32 s32, s30, 5
    s_mov_b32 s21, 8192
    s_mov_b32 s33, 0x400000
    s_mov_b32 s29, 2
    s_cmp_lt_u32 s2, 512
    s_cbranch_scc1 proj_j0
    s_cmp_lt_u32 s2, 1024
    s_cbranch_scc1 proj_j1
    s_cmp_lt_u32 s2, 1536
    s_cbranch_scc1 proj_j2
    s_cmp_lt_u32 s2, 1600
    s_cbranch_scc1 proj_j3
    s_cmp_lt_u32 s2, 1616
    s_cbranch_scc1 proj_j4
    s_sub_u32 s32, s2, 1616
    s_mov_b32 s31, 0
    s_mov_b64 s[64:65], s[42:43]
    s_mov_b64 s[66:67], s[36:37]
    s_mov_b32 s21, 32
    s_mov_b32 s33, 16384
    s_mov_b32 s22, 0
    s_mov_b32 s23, 72351744
    s_mov_b32 s24, 2048
    s_mov_b32 s25, 0
    s_mov_b32 s26, 1024
    s_mov_b32 s29, 0
    s_branch proj_go
proj_j4:
    s_sub_u32 s32, s2, 1600
    s_mov_b32 s31, 0
    s_mov_b64 s[64:65], s[40:41]
    s_mov_b64 s[66:67], s[36:37]
    s_mov_b32 s21, 32
    s_mov_b32 s33, 16384
    s_mov_b32 s22, 1
    s_mov_b32 s23, 71303168
    s_mov_b32 s24, 1024
    s_mov_b32 s25, 0
    s_mov_b32 s26, 0
    s_mov_b32 s29, 1
    s_branch proj_go
proj_j3:
    s_sub_u32 s30, s2, 1536
    s_and_b32 s31, s30, 3
    s_lshr_b32 s32, s30, 2
    s_mov_b64 s[64:65], s[38:39]
    s_mov_b64 s[66:67], s[36:37]
    s_mov_b32 s21, 1024
    s_mov_b32 s33, 0x80000
    s_mov_b32 s22, 1
    s_lshl_b32 s23, s31, 13
    s_add_u32 s23, s23, 67108864
    s_mov_b32 s24, 32768
    s_mov_b32 s25, 2048
    s_mov_b32 s26, 1024
    s_branch proj_go
proj_j2:
    s_mov_b64 s[64:65], s[54:55]
    s_mov_b64 s[66:67], s[48:49]
    s_mov_b32 s22, 0
    s_lshl_b32 s23, s31, 19
    s_add_u32 s23, s23, 33554432
    s_mov_b32 s24, 8192
    s_mov_b32 s25, 1024
    s_mov_b32 s26, 4096
    s_branch proj_go
proj_j1:
    s_mov_b64 s[64:65], s[52:53]
    s_mov_b64 s[66:67], s[48:49]
    s_mov_b32 s22, 1
    s_lshl_b32 s23, s31, 19
    s_add_u32 s23, s23, 16777216
    s_mov_b32 s24, 8192
    s_mov_b32 s25, 2048
    s_mov_b32 s26, 1024
    s_branch proj_go
proj_j0:
    s_mov_b64 s[64:65], s[50:51]
    s_mov_b64 s[66:67], s[46:47]
    s_mov_b32 s22, 1
    s_lshl_b32 s23, s31, 19
    s_add_u32 s23, s23, 0
    s_mov_b32 s24, 8192
    s_mov_b32 s25, 2048
    s_mov_b32 s26, 1024
proj_go:
    s_mov_b32 s4, s64
    s_and_b32 s5, s65, 0xffff
    s_mov_b32 s6, s33
    s_mov_b32 s7, 0x00020000
    s_mov_b32 s8, s66
    s_and_b32 s9, s67, 0xffff
    s_mov_b32 s10, 2097152
    s_mov_b32 s11, 0x00020000
    s_mov_b32 s12, s62
    s_and_b32 s13, s63, 0xffff
    s_mov_b32 s14, 268435456
    s_mov_b32 s15, 0x00020000
    v_and_b32 v11, 31, v0
    v_lshrrev_b32 v12, 5, v0
    v_and_b32 v13, 7, v0
    s_lshl_b32 s30, s18, 13
    v_or_b32 v14, 0, v12
    v_xor_b32 v14, v14, v13
    v_lshlrev_b32 v14, 4, v14
    v_lshl_add_u32 v2, v11, 7, v14
    v_add_u32 v2, s30, v2
    v_or_b32 v14, 2, v12
    v_xor_b32 v14, v14, v13
    v_lshlrev_b32 v14, 4, v14
    v_lshl_add_u32 v3, v11, 7, v14
    v_add_u32 v3, s30, v3
    v_or_b32 v14, 4, v12
    v_xor_b32 v14, v14, v13
    v_lshlrev_b32 v14, 4, v14
    v_lshl_add_u32 v4, v11, 7, v14
    v_add_u32 v4, s30, v4
    v_or_b32 v14, 6, v12
    v_xor_b32 v14, v14, v13
    v_lshlrev_b32 v14, 4, v14
    v_lshl_add_u32 v5, v11, 7, v14
    v_add_u32 v5, s30, v5
    v_lshrrev_b32 v14, 4, v0
    v_and_b32 v14, 1, v14
    v_and_b32 v15, 15, v0
    v_lshrrev_b32 v16, 2, v15
    v_and_b32 v17, 3, v15
    v_lshl_add_u32 v18, v12, 3, v16
    v_lshlrev_b32 v18, 8, v18
    v_and_b32 v19, 1, v17
    v_lshl_add_u32 v18, v19, 3, v18
    v_lshrrev_b32 v19, 1, v17
    v_lshl_add_u32 v19, v14, 1, v19
    v_lshlrev_b32 v20, 2, v16
    s_lshl_b32 s30, s17, 3
    s_add_u32 s30, s30, 0
    v_add_u32 v21, s30, v19
    v_xor_b32 v21, v21, v20
    v_lshl_add_u32 v6, v21, 4, v18
    v_add_u32 v6, 16384, v6
    s_lshl_b32 s30, s17, 3
    s_add_u32 s30, s30, 4
    v_add_u32 v21, s30, v19
    v_xor_b32 v21, v21, v20
    v_lshl_add_u32 v7, v21, 4, v18
    v_add_u32 v7, 16384, v7
    v_lshrrev_b32 v14, 3, v0
    v_and_b32 v15, 7, v0
    v_xor_b32 v15, v15, v14
    v_lshlrev_b32 v15, 4, v15
    v_lshl_add_u32 v8, v14, 10, v15
    v_lshrrev_b32 v14, 4, v0
    v_and_b32 v15, 15, v0
    v_lshlrev_b32 v16, 2, v14
    v_xor_b32 v15, v15, v16
    v_lshlrev_b32 v15, 4, v15
    v_mul_lo_u32 v16, v14, s21
    v_add_u32 v9, v15, v16
    v_lshlrev_b32 v10, 4, v0
    s_lshl_b32 s27, s32, 17
    s_lshl_b32 s30, s16, 15
    s_add_u32 s27, s27, s30
    s_lshl_b32 s30, s16, 4
    s_mul_i32 s28, s30, s21
    s_lshl_b32 s30, s31, 8
    s_add_u32 s28, s28, s30
    s_lshl_b32 s34, s21, 2
    s_lshl_b32 s35, s21, 6
    s_lshl_b32 s68, s16, 12
    v_mov_b32 v64, 0
    v_mov_b32 v65, 0
    v_mov_b32 v66, 0
    v_mov_b32 v67, 0
    v_mov_b32 v68, 0
    v_mov_b32 v69, 0
    v_mov_b32 v70, 0
    v_mov_b32 v71, 0
    v_mov_b32 v72, 0
    v_mov_b32 v73, 0
    v_mov_b32 v74, 0
    v_mov_b32 v75, 0
    v_mov_b32 v76, 0
    v_mov_b32 v77, 0
    v_mov_b32 v78, 0
    v_mov_b32 v79, 0
    v_mov_b32 v80, 0
    v_mov_b32 v81, 0
    v_mov_b32 v82, 0
    v_mov_b32 v83, 0
    v_mov_b32 v84, 0
    v_mov_b32 v85, 0
    v_mov_b32 v86, 0
    v_mov_b32 v87, 0
    v_mov_b32 v88, 0
    v_mov_b32 v89, 0
    v_mov_b32 v90, 0
    v_mov_b32 v91, 0
    v_mov_b32 v92, 0
    v_mov_b32 v93, 0
    v_mov_b32 v94, 0
    v_mov_b32 v95, 0
    v_mov_b32 v96, 0
    v_mov_b32 v97, 0
    v_mov_b32 v98, 0
    v_mov_b32 v99, 0
    v_mov_b32 v100, 0
    v_mov_b32 v101, 0
    v_mov_b32 v102, 0
    v_mov_b32 v103, 0
    v_mov_b32 v104, 0
    v_mov_b32 v105, 0
    v_mov_b32 v106, 0
    v_mov_b32 v107, 0
    v_mov_b32 v108, 0
    v_mov_b32 v109, 0
    v_mov_b32 v110, 0
    v_mov_b32 v111, 0
    v_mov_b32 v112, 0
    v_mov_b32 v113, 0
    v_mov_b32 v114, 0
    v_mov_b32 v115, 0
    v_mov_b32 v116, 0
    v_mov_b32 v117, 0
    v_mov_b32 v118, 0
    v_mov_b32 v119, 0
    v_mov_b32 v120, 0
    v_mov_b32 v121, 0
    v_mov_b32 v122, 0
    v_mov_b32 v123, 0
    v_mov_b32 v124, 0
    v_mov_b32 v125, 0
    v_mov_b32 v126, 0
    v_mov_b32 v127, 0
    s_add_u32 s69, s68, 0
    s_mov_b32 s70, s27
    s_mov_b32 m0, s69
    s_add_u32 s69, s69, 1024
    buffer_load_dwordx4 v8, s[8:11], s70 offen lds
    s_add_u32 s70, s70, 8192
    s_mov_b32 m0, s69
    s_add_u32 s69, s69, 1024
    buffer_load_dwordx4 v8, s[8:11], s70 offen lds
    s_add_u32 s70, s70, 8192
    s_mov_b32 m0, s69
    s_add_u32 s69, s69, 1024
    buffer_load_dwordx4 v8, s[8:11], s70 offen lds
    s_add_u32 s70, s70, 8192
    s_mov_b32 m0, s69
    s_add_u32 s69, s69, 1024
    buffer_load_dwordx4 v8, s[8:11], s70 offen lds
    s_add_u32 s70, s70, 8192
    s_add_u32 s69, s68, 16384
    s_mov_b32 s70, s28
    s_mov_b32 m0, s69
    s_add_u32 s69, s69, 1024
    buffer_load_dwordx4 v9, s[4:7], s70 offen lds
    s_add_u32 s70, s70, s34
    s_mov_b32 m0, s69
    s_add_u32 s69, s69, 1024
    buffer_load_dwordx4 v9, s[4:7], s70 offen lds
    s_add_u32 s70, s70, s34
    s_mov_b32 m0, s69
    s_add_u32 s69, s69, 1024
    buffer_load_dwordx4 v9, s[4:7], s70 offen lds
    s_add_u32 s70, s70, s34
    s_mov_b32 m0, s69
    s_add_u32 s69, s69, 1024
    buffer_load_dwordx4 v9, s[4:7], s70 offen lds
    s_add_u32 s70, s70, s34
    s_add_u32 s27, s27, 128
    s_add_u32 s28, s28, s35
    s_waitcnt vmcnt(0)
    s_barrier
    s_cmp_eq_u32 s22, 0
    s_cbranch_scc1 proj_nt
    s_add_u32 s69, s68, 32768
    s_mov_b32 s70, s27
    s_mov_b32 m0, s69
    s_add_u32 s69, s69, 1024
    buffer_load_dwordx4 v8, s[8:11], s70 offen lds
    s_add_u32 s70, s70, 8192
    s_mov_b32 m0, s69
    s_add_u32 s69, s69, 1024
    buffer_load_dwordx4 v8, s[8:11], s70 offen lds
    s_add_u32 s70, s70, 8192
    s_mov_b32 m0, s69
    s_add_u32 s69, s69, 1024
    buffer_load_dwordx4 v8, s[8:11], s70 offen lds
    s_add_u32 s70, s70, 8192
    s_mov_b32 m0, s69
    s_add_u32 s69, s69, 1024
    buffer_load_dwordx4 v8, s[8:11], s70 offen lds
    s_add_u32 s70, s70, 8192
    s_add_u32 s69, s68, 49152
    s_mov_b32 s70, s28
    s_mov_b32 m0, s69
    s_add_u32 s69, s69, 1024
    buffer_load_dwordx4 v9, s[4:7], s70 offen lds
    s_add_u32 s70, s70, s34
    s_mov_b32 m0, s69
    s_add_u32 s69, s69, 1024
    buffer_load_dwordx4 v9, s[4:7], s70 offen lds
    s_add_u32 s70, s70, s34
    s_mov_b32 m0, s69
    s_add_u32 s69, s69, 1024
    buffer_load_dwordx4 v9, s[4:7], s70 offen lds
    s_add_u32 s70, s70, s34
    s_mov_b32 m0, s69
    s_add_u32 s69, s69, 1024
    buffer_load_dwordx4 v9, s[4:7], s70 offen lds
    s_add_u32 s70, s70, s34
    s_add_u32 s27, s27, 128
    s_add_u32 s28, s28, s35
    ds_read_b64_tr_b16 v[32:33], v6 offset:0
    ds_read_b64_tr_b16 v[34:35], v6 offset:1024
    ds_read_b64_tr_b16 v[36:37], v7 offset:0
    ds_read_b64_tr_b16 v[38:39], v7 offset:1024
    ds_read_b128 v[40:43], v2 offset:0
    ds_read_b128 v[44:47], v2 offset:4096
    ds_read_b64_tr_b16 v[48:49], v6 offset:4096
    ds_read_b64_tr_b16 v[50:51], v6 offset:5120
    ds_read_b64_tr_b16 v[52:53], v7 offset:4096
    ds_read_b64_tr_b16 v[54:55], v7 offset:5120
    ds_read_b128 v[56:59], v3 offset:0
    ds_read_b128 v[60:63], v3 offset:4096
    s_waitcnt lgkmcnt(6)
    v_mfma_f32_32x32x16_bf16 v[64:79], v[32:35], v[40:43], v[64:79]
    v_mfma_f32_32x32x16_bf16 v[80:95], v[32:35], v[44:47], v[80:95]
    v_mfma_f32_32x32x16_bf16 v[96:111], v[36:39], v[40:43], v[96:111]
    v_mfma_f32_32x32x16_bf16 v[112:127], v[36:39], v[44:47], v[112:127]
    ds_read_b64_tr_b16 v[32:33], v6 offset:8192
    ds_read_b64_tr_b16 v[34:35], v6 offset:9216
    ds_read_b64_tr_b16 v[36:37], v7 offset:8192
    ds_read_b64_tr_b16 v[38:39], v7 offset:9216
    ds_read_b128 v[40:43], v4 offset:0
    ds_read_b128 v[44:47], v4 offset:4096
    s_waitcnt lgkmcnt(6)
    v_mfma_f32_32x32x16_bf16 v[64:79], v[48:51], v[56:59], v[64:79]
    v_mfma_f32_32x32x16_bf16 v[80:95], v[48:51], v[60:63], v[80:95]
    v_mfma_f32_32x32x16_bf16 v[96:111], v[52:55], v[56:59], v[96:111]
    v_mfma_f32_32x32x16_bf16 v[112:127], v[52:55], v[60:63], v[112:127]
    ds_read_b64_tr_b16 v[48:49], v6 offset:12288
    ds_read_b64_tr_b16 v[50:51], v6 offset:13312
    ds_read_b64_tr_b16 v[52:53], v7 offset:12288
    ds_read_b64_tr_b16 v[54:55], v7 offset:13312
    ds_read_b128 v[56:59], v5 offset:0
    ds_read_b128 v[60:63], v5 offset:4096
    s_waitcnt lgkmcnt(6)
    v_mfma_f32_32x32x16_bf16 v[64:79], v[32:35], v[40:43], v[64:79]
    v_mfma_f32_32x32x16_bf16 v[80:95], v[32:35], v[44:47], v[80:95]
    v_mfma_f32_32x32x16_bf16 v[96:111], v[36:39], v[40:43], v[96:111]
    v_mfma_f32_32x32x16_bf16 v[112:127], v[36:39], v[44:47], v[112:127]
    s_waitcnt lgkmcnt(0)
    v_mfma_f32_32x32x16_bf16 v[64:79], v[48:51], v[56:59], v[64:79]
    v_mfma_f32_32x32x16_bf16 v[80:95], v[48:51], v[60:63], v[80:95]
    v_mfma_f32_32x32x16_bf16 v[96:111], v[52:55], v[56:59], v[96:111]
    v_mfma_f32_32x32x16_bf16 v[112:127], v[52:55], v[60:63], v[112:127]
    s_waitcnt vmcnt(0)
    s_barrier
    s_add_u32 s69, s68, 0
    s_mov_b32 s70, s27
    s_mov_b32 m0, s69
    s_add_u32 s69, s69, 1024
    buffer_load_dwordx4 v8, s[8:11], s70 offen lds
    s_add_u32 s70, s70, 8192
    s_mov_b32 m0, s69
    s_add_u32 s69, s69, 1024
    buffer_load_dwordx4 v8, s[8:11], s70 offen lds
    s_add_u32 s70, s70, 8192
    s_mov_b32 m0, s69
    s_add_u32 s69, s69, 1024
    buffer_load_dwordx4 v8, s[8:11], s70 offen lds
    s_add_u32 s70, s70, 8192
    s_mov_b32 m0, s69
    s_add_u32 s69, s69, 1024
    buffer_load_dwordx4 v8, s[8:11], s70 offen lds
    s_add_u32 s70, s70, 8192
    s_add_u32 s69, s68, 16384
    s_mov_b32 s70, s28
    s_mov_b32 m0, s69
    s_add_u32 s69, s69, 1024
    buffer_load_dwordx4 v9, s[4:7], s70 offen lds
    s_add_u32 s70, s70, s34
    s_mov_b32 m0, s69
    s_add_u32 s69, s69, 1024
    buffer_load_dwordx4 v9, s[4:7], s70 offen lds
    s_add_u32 s70, s70, s34
    s_mov_b32 m0, s69
    s_add_u32 s69, s69, 1024
    buffer_load_dwordx4 v9, s[4:7], s70 offen lds
    s_add_u32 s70, s70, s34
    s_mov_b32 m0, s69
    s_add_u32 s69, s69, 1024
    buffer_load_dwordx4 v9, s[4:7], s70 offen lds
    s_add_u32 s70, s70, s34
    s_add_u32 s27, s27, 128
    s_add_u32 s28, s28, s35
    ds_read_b64_tr_b16 v[32:33], v6 offset:32768
    ds_read_b64_tr_b16 v[34:35], v6 offset:33792
    ds_read_b64_tr_b16 v[36:37], v7 offset:32768
    ds_read_b64_tr_b16 v[38:39], v7 offset:33792
    ds_read_b128 v[40:43], v2 offset:32768
    ds_read_b128 v[44:47], v2 offset:36864
    ds_read_b64_tr_b16 v[48:49], v6 offset:36864
    ds_read_b64_tr_b16 v[50:51], v6 offset:37888
    ds_read_b64_tr_b16 v[52:53], v7 offset:36864
    ds_read_b64_tr_b16 v[54:55], v7 offset:37888
    ds_read_b128 v[56:59], v3 offset:32768
    ds_read_b128 v[60:63], v3 offset:36864
    s_waitcnt lgkmcnt(6)
    v_mfma_f32_32x32x16_bf16 v[64:79], v[32:35], v[40:43], v[64:79]
    v_mfma_f32_32x32x16_bf16 v[80:95], v[32:35], v[44:47], v[80:95]
    v_mfma_f32_32x32x16_bf16 v[96:111], v[36:39], v[40:43], v[96:111]
    v_mfma_f32_32x32x16_bf16 v[112:127], v[36:39], v[44:47], v[112:127]
    ds_read_b64_tr_b16 v[32:33], v6 offset:40960
    ds_read_b64_tr_b16 v[34:35], v6 offset:41984
    ds_read_b64_tr_b16 v[36:37], v7 offset:40960
    ds_read_b64_tr_b16 v[38:39], v7 offset:41984
    ds_read_b128 v[40:43], v4 offset:32768
    ds_read_b128 v[44:47], v4 offset:36864
    s_waitcnt lgkmcnt(6)
    v_mfma_f32_32x32x16_bf16 v[64:79], v[48:51], v[56:59], v[64:79]
    v_mfma_f32_32x32x16_bf16 v[80:95], v[48:51], v[60:63], v[80:95]
    v_mfma_f32_32x32x16_bf16 v[96:111], v[52:55], v[56:59], v[96:111]
    v_mfma_f32_32x32x16_bf16 v[112:127], v[52:55], v[60:63], v[112:127]
    ds_read_b64_tr_b16 v[48:49], v6 offset:45056
    ds_read_b64_tr_b16 v[50:51], v6 offset:46080
    ds_read_b64_tr_b16 v[52:53], v7 offset:45056
    ds_read_b64_tr_b16 v[54:55], v7 offset:46080
    ds_read_b128 v[56:59], v5 offset:32768
    ds_read_b128 v[60:63], v5 offset:36864
    s_waitcnt lgkmcnt(6)
    v_mfma_f32_32x32x16_bf16 v[64:79], v[32:35], v[40:43], v[64:79]
    v_mfma_f32_32x32x16_bf16 v[80:95], v[32:35], v[44:47], v[80:95]
    v_mfma_f32_32x32x16_bf16 v[96:111], v[36:39], v[40:43], v[96:111]
    v_mfma_f32_32x32x16_bf16 v[112:127], v[36:39], v[44:47], v[112:127]
    s_waitcnt lgkmcnt(0)
    v_mfma_f32_32x32x16_bf16 v[64:79], v[48:51], v[56:59], v[64:79]
    v_mfma_f32_32x32x16_bf16 v[80:95], v[48:51], v[60:63], v[80:95]
    v_mfma_f32_32x32x16_bf16 v[96:111], v[52:55], v[56:59], v[96:111]
    v_mfma_f32_32x32x16_bf16 v[112:127], v[52:55], v[60:63], v[112:127]
    s_waitcnt vmcnt(0)
    s_barrier
    s_add_u32 s69, s68, 32768
    s_mov_b32 s70, s27
    s_mov_b32 m0, s69
    s_add_u32 s69, s69, 1024
    buffer_load_dwordx4 v8, s[8:11], s70 offen lds
    s_add_u32 s70, s70, 8192
    s_mov_b32 m0, s69
    s_add_u32 s69, s69, 1024
    buffer_load_dwordx4 v8, s[8:11], s70 offen lds
    s_add_u32 s70, s70, 8192
    s_mov_b32 m0, s69
    s_add_u32 s69, s69, 1024
    buffer_load_dwordx4 v8, s[8:11], s70 offen lds
    s_add_u32 s70, s70, 8192
    s_mov_b32 m0, s69
    s_add_u32 s69, s69, 1024
    buffer_load_dwordx4 v8, s[8:11], s70 offen lds
    s_add_u32 s70, s70, 8192
    s_add_u32 s69, s68, 49152
    s_mov_b32 s70, s28
    s_mov_b32 m0, s69
    s_add_u32 s69, s69, 1024
    buffer_load_dwordx4 v9, s[4:7], s70 offen lds
    s_add_u32 s70, s70, s34
    s_mov_b32 m0, s69
    s_add_u32 s69, s69, 1024
    buffer_load_dwordx4 v9, s[4:7], s70 offen lds
    s_add_u32 s70, s70, s34
    s_mov_b32 m0, s69
    s_add_u32 s69, s69, 1024
    buffer_load_dwordx4 v9, s[4:7], s70 offen lds
    s_add_u32 s70, s70, s34
    s_mov_b32 m0, s69
    s_add_u32 s69, s69, 1024
    buffer_load_dwordx4 v9, s[4:7], s70 offen lds
    s_add_u32 s70, s70, s34
    s_add_u32 s27, s27, 128
    s_add_u32 s28, s28, s35
    ds_read_b64_tr_b16 v[32:33], v6 offset:0
    ds_read_b64_tr_b16 v[34:35], v6 offset:1024
    ds_read_b64_tr_b16 v[36:37], v7 offset:0
    ds_read_b64_tr_b16 v[38:39], v7 offset:1024
    ds_read_b128 v[40:43], v2 offset:0
    ds_read_b128 v[44:47], v2 offset:4096
    ds_read_b64_tr_b16 v[48:49], v6 offset:4096
    ds_read_b64_tr_b16 v[50:51], v6 offset:5120
    ds_read_b64_tr_b16 v[52:53], v7 offset:4096
    ds_read_b64_tr_b16 v[54:55], v7 offset:5120
    ds_read_b128 v[56:59], v3 offset:0
    ds_read_b128 v[60:63], v3 offset:4096
    s_waitcnt lgkmcnt(6)
    v_mfma_f32_32x32x16_bf16 v[64:79], v[32:35], v[40:43], v[64:79]
    v_mfma_f32_32x32x16_bf16 v[80:95], v[32:35], v[44:47], v[80:95]
    v_mfma_f32_32x32x16_bf16 v[96:111], v[36:39], v[40:43], v[96:111]
    v_mfma_f32_32x32x16_bf16 v[112:127], v[36:39], v[44:47], v[112:127]
    ds_read_b64_tr_b16 v[32:33], v6 offset:8192
    ds_read_b64_tr_b16 v[34:35], v6 offset:9216
    ds_read_b64_tr_b16 v[36:37], v7 offset:8192
    ds_read_b64_tr_b16 v[38:39], v7 offset:9216
    ds_read_b128 v[40:43], v4 offset:0
    ds_read_b128 v[44:47], v4 offset:4096
    s_waitcnt lgkmcnt(6)
    v_mfma_f32_32x32x16_bf16 v[64:79], v[48:51], v[56:59], v[64:79]
    v_mfma_f32_32x32x16_bf16 v[80:95], v[48:51], v[60:63], v[80:95]
    v_mfma_f32_32x32x16_bf16 v[96:111], v[52:55], v[56:59], v[96:111]
    v_mfma_f32_32x32x16_bf16 v[112:127], v[52:55], v[60:63], v[112:127]
    ds_read_b64_tr_b16 v[48:49], v6 offset:12288
    ds_read_b64_tr_b16 v[50:51], v6 offset:13312
    ds_read_b64_tr_b16 v[52:53], v7 offset:12288
    ds_read_b64_tr_b16 v[54:55], v7 offset:13312
    ds_read_b128 v[56:59], v5 offset:0
    ds_read_b128 v[60:63], v5 offset:4096
    s_waitcnt lgkmcnt(6)
    v_mfma_f32_32x32x16_bf16 v[64:79], v[32:35], v[40:43], v[64:79]
    v_mfma_f32_32x32x16_bf16 v[80:95], v[32:35], v[44:47], v[80:95]
    v_mfma_f32_32x32x16_bf16 v[96:111], v[36:39], v[40:43], v[96:111]
    v_mfma_f32_32x32x16_bf16 v[112:127], v[36:39], v[44:47], v[112:127]
    s_waitcnt lgkmcnt(0)
    v_mfma_f32_32x32x16_bf16 v[64:79], v[48:51], v[56:59], v[64:79]
    v_mfma_f32_32x32x16_bf16 v[80:95], v[48:51], v[60:63], v[80:95]
    v_mfma_f32_32x32x16_bf16 v[96:111], v[52:55], v[56:59], v[96:111]
    v_mfma_f32_32x32x16_bf16 v[112:127], v[52:55], v[60:63], v[112:127]
    s_waitcnt vmcnt(0)
    s_barrier
    s_add_u32 s69, s68, 0
    s_mov_b32 s70, s27
    s_mov_b32 m0, s69
    s_add_u32 s69, s69, 1024
    buffer_load_dwordx4 v8, s[8:11], s70 offen lds
    s_add_u32 s70, s70, 8192
    s_mov_b32 m0, s69
    s_add_u32 s69, s69, 1024
    buffer_load_dwordx4 v8, s[8:11], s70 offen lds
    s_add_u32 s70, s70, 8192
    s_mov_b32 m0, s69
    s_add_u32 s69, s69, 1024
    buffer_load_dwordx4 v8, s[8:11], s70 offen lds
    s_add_u32 s70, s70, 8192
    s_mov_b32 m0, s69
    s_add_u32 s69, s69, 1024
    buffer_load_dwordx4 v8, s[8:11], s70 offen lds
    s_add_u32 s70, s70, 8192
    s_add_u32 s69, s68, 16384
    s_mov_b32 s70, s28
    s_mov_b32 m0, s69
    s_add_u32 s69, s69, 1024
    buffer_load_dwordx4 v9, s[4:7], s70 offen lds
    s_add_u32 s70, s70, s34
    s_mov_b32 m0, s69
    s_add_u32 s69, s69, 1024
    buffer_load_dwordx4 v9, s[4:7], s70 offen lds
    s_add_u32 s70, s70, s34
    s_mov_b32 m0, s69
    s_add_u32 s69, s69, 1024
    buffer_load_dwordx4 v9, s[4:7], s70 offen lds
    s_add_u32 s70, s70, s34
    s_mov_b32 m0, s69
    s_add_u32 s69, s69, 1024
    buffer_load_dwordx4 v9, s[4:7], s70 offen lds
    s_add_u32 s70, s70, s34
    s_add_u32 s27, s27, 128
    s_add_u32 s28, s28, s35
    ds_read_b64_tr_b16 v[32:33], v6 offset:32768
    ds_read_b64_tr_b16 v[34:35], v6 offset:33792
    ds_read_b64_tr_b16 v[36:37], v7 offset:32768
    ds_read_b64_tr_b16 v[38:39], v7 offset:33792
    ds_read_b128 v[40:43], v2 offset:32768
    ds_read_b128 v[44:47], v2 offset:36864
    ds_read_b64_tr_b16 v[48:49], v6 offset:36864
    ds_read_b64_tr_b16 v[50:51], v6 offset:37888
    ds_read_b64_tr_b16 v[52:53], v7 offset:36864
    ds_read_b64_tr_b16 v[54:55], v7 offset:37888
    ds_read_b128 v[56:59], v3 offset:32768
    ds_read_b128 v[60:63], v3 offset:36864
    s_waitcnt lgkmcnt(6)
    v_mfma_f32_32x32x16_bf16 v[64:79], v[32:35], v[40:43], v[64:79]
    v_mfma_f32_32x32x16_bf16 v[80:95], v[32:35], v[44:47], v[80:95]
    v_mfma_f32_32x32x16_bf16 v[96:111], v[36:39], v[40:43], v[96:111]
    v_mfma_f32_32x32x16_bf16 v[112:127], v[36:39], v[44:47], v[112:127]
    ds_read_b64_tr_b16 v[32:33], v6 offset:40960
    ds_read_b64_tr_b16 v[34:35], v6 offset:41984
    ds_read_b64_tr_b16 v[36:37], v7 offset:40960
    ds_read_b64_tr_b16 v[38:39], v7 offset:41984
    ds_read_b128 v[40:43], v4 offset:32768
    ds_read_b128 v[44:47], v4 offset:36864
    s_waitcnt lgkmcnt(6)
    v_mfma_f32_32x32x16_bf16 v[64:79], v[48:51], v[56:59], v[64:79]
    v_mfma_f32_32x32x16_bf16 v[80:95], v[48:51], v[60:63], v[80:95]
    v_mfma_f32_32x32x16_bf16 v[96:111], v[52:55], v[56:59], v[96:111]
    v_mfma_f32_32x32x16_bf16 v[112:127], v[52:55], v[60:63], v[112:127]
    ds_read_b64_tr_b16 v[48:49], v6 offset:45056
    ds_read_b64_tr_b16 v[50:51], v6 offset:46080
    ds_read_b64_tr_b16 v[52:53], v7 offset:45056
    ds_read_b64_tr_b16 v[54:55], v7 offset:46080
    ds_read_b128 v[56:59], v5 offset:32768
    ds_read_b128 v[60:63], v5 offset:36864
    s_waitcnt lgkmcnt(6)
    v_mfma_f32_32x32x16_bf16 v[64:79], v[32:35], v[40:43], v[64:79]
    v_mfma_f32_32x32x16_bf16 v[80:95], v[32:35], v[44:47], v[80:95]
    v_mfma_f32_32x32x16_bf16 v[96:111], v[36:39], v[40:43], v[96:111]
    v_mfma_f32_32x32x16_bf16 v[112:127], v[36:39], v[44:47], v[112:127]
    s_waitcnt lgkmcnt(0)
    v_mfma_f32_32x32x16_bf16 v[64:79], v[48:51], v[56:59], v[64:79]
    v_mfma_f32_32x32x16_bf16 v[80:95], v[48:51], v[60:63], v[80:95]
    v_mfma_f32_32x32x16_bf16 v[96:111], v[52:55], v[56:59], v[96:111]
    v_mfma_f32_32x32x16_bf16 v[112:127], v[52:55], v[60:63], v[112:127]
    s_waitcnt vmcnt(0)
    s_barrier
    s_add_u32 s69, s68, 32768
    s_mov_b32 s70, s27
    s_mov_b32 m0, s69
    s_add_u32 s69, s69, 1024
    buffer_load_dwordx4 v8, s[8:11], s70 offen lds
    s_add_u32 s70, s70, 8192
    s_mov_b32 m0, s69
    s_add_u32 s69, s69, 1024
    buffer_load_dwordx4 v8, s[8:11], s70 offen lds
    s_add_u32 s70, s70, 8192
    s_mov_b32 m0, s69
    s_add_u32 s69, s69, 1024
    buffer_load_dwordx4 v8, s[8:11], s70 offen lds
    s_add_u32 s70, s70, 8192
    s_mov_b32 m0, s69
    s_add_u32 s69, s69, 1024
    buffer_load_dwordx4 v8, s[8:11], s70 offen lds
    s_add_u32 s70, s70, 8192
    s_add_u32 s69, s68, 49152
    s_mov_b32 s70, s28
    s_mov_b32 m0, s69
    s_add_u32 s69, s69, 1024
    buffer_load_dwordx4 v9, s[4:7], s70 offen lds
    s_add_u32 s70, s70, s34
    s_mov_b32 m0, s69
    s_add_u32 s69, s69, 1024
    buffer_load_dwordx4 v9, s[4:7], s70 offen lds
    s_add_u32 s70, s70, s34
    s_mov_b32 m0, s69
    s_add_u32 s69, s69, 1024
    buffer_load_dwordx4 v9, s[4:7], s70 offen lds
    s_add_u32 s70, s70, s34
    s_mov_b32 m0, s69
    s_add_u32 s69, s69, 1024
    buffer_load_dwordx4 v9, s[4:7], s70 offen lds
    s_add_u32 s70, s70, s34
    s_add_u32 s27, s27, 128
    s_add_u32 s28, s28, s35
    ds_read_b64_tr_b16 v[32:33], v6 offset:0
    ds_read_b64_tr_b16 v[34:35], v6 offset:1024
    ds_read_b64_tr_b16 v[36:37], v7 offset:0
    ds_read_b64_tr_b16 v[38:39], v7 offset:1024
    ds_read_b128 v[40:43], v2 offset:0
    ds_read_b128 v[44:47], v2 offset:4096
    ds_read_b64_tr_b16 v[48:49], v6 offset:4096
    ds_read_b64_tr_b16 v[50:51], v6 offset:5120
    ds_read_b64_tr_b16 v[52:53], v7 offset:4096
    ds_read_b64_tr_b16 v[54:55], v7 offset:5120
    ds_read_b128 v[56:59], v3 offset:0
    ds_read_b128 v[60:63], v3 offset:4096
    s_waitcnt lgkmcnt(6)
    v_mfma_f32_32x32x16_bf16 v[64:79], v[32:35], v[40:43], v[64:79]
    v_mfma_f32_32x32x16_bf16 v[80:95], v[32:35], v[44:47], v[80:95]
    v_mfma_f32_32x32x16_bf16 v[96:111], v[36:39], v[40:43], v[96:111]
    v_mfma_f32_32x32x16_bf16 v[112:127], v[36:39], v[44:47], v[112:127]
    ds_read_b64_tr_b16 v[32:33], v6 offset:8192
    ds_read_b64_tr_b16 v[34:35], v6 offset:9216
    ds_read_b64_tr_b16 v[36:37], v7 offset:8192
    ds_read_b64_tr_b16 v[38:39], v7 offset:9216
    ds_read_b128 v[40:43], v4 offset:0
    ds_read_b128 v[44:47], v4 offset:4096
    s_waitcnt lgkmcnt(6)
    v_mfma_f32_32x32x16_bf16 v[64:79], v[48:51], v[56:59], v[64:79]
    v_mfma_f32_32x32x16_bf16 v[80:95], v[48:51], v[60:63], v[80:95]
    v_mfma_f32_32x32x16_bf16 v[96:111], v[52:55], v[56:59], v[96:111]
    v_mfma_f32_32x32x16_bf16 v[112:127], v[52:55], v[60:63], v[112:127]
    ds_read_b64_tr_b16 v[48:49], v6 offset:12288
    ds_read_b64_tr_b16 v[50:51], v6 offset:13312
    ds_read_b64_tr_b16 v[52:53], v7 offset:12288
    ds_read_b64_tr_b16 v[54:55], v7 offset:13312
    ds_read_b128 v[56:59], v5 offset:0
    ds_read_b128 v[60:63], v5 offset:4096
    s_waitcnt lgkmcnt(6)
    v_mfma_f32_32x32x16_bf16 v[64:79], v[32:35], v[40:43], v[64:79]
    v_mfma_f32_32x32x16_bf16 v[80:95], v[32:35], v[44:47], v[80:95]
    v_mfma_f32_32x32x16_bf16 v[96:111], v[36:39], v[40:43], v[96:111]
    v_mfma_f32_32x32x16_bf16 v[112:127], v[36:39], v[44:47], v[112:127]
    s_waitcnt lgkmcnt(0)
    v_mfma_f32_32x32x16_bf16 v[64:79], v[48:51], v[56:59], v[64:79]
    v_mfma_f32_32x32x16_bf16 v[80:95], v[48:51], v[60:63], v[80:95]
    v_mfma_f32_32x32x16_bf16 v[96:111], v[52:55], v[56:59], v[96:111]
    v_mfma_f32_32x32x16_bf16 v[112:127], v[52:55], v[60:63], v[112:127]
    s_waitcnt vmcnt(0)
    s_barrier
    s_add_u32 s69, s68, 0
    s_mov_b32 s70, s27
    s_mov_b32 m0, s69
    s_add_u32 s69, s69, 1024
    buffer_load_dwordx4 v8, s[8:11], s70 offen lds
    s_add_u32 s70, s70, 8192
    s_mov_b32 m0, s69
    s_add_u32 s69, s69, 1024
    buffer_load_dwordx4 v8, s[8:11], s70 offen lds
    s_add_u32 s70, s70, 8192
    s_mov_b32 m0, s69
    s_add_u32 s69, s69, 1024
    buffer_load_dwordx4 v8, s[8:11], s70 offen lds
    s_add_u32 s70, s70, 8192
    s_mov_b32 m0, s69
    s_add_u32 s69, s69, 1024
    buffer_load_dwordx4 v8, s[8:11], s70 offen lds
    s_add_u32 s70, s70, 8192
    s_add_u32 s69, s68, 16384
    s_mov_b32 s70, s28
    s_mov_b32 m0, s69
    s_add_u32 s69, s69, 1024
    buffer_load_dwordx4 v9, s[4:7], s70 offen lds
    s_add_u32 s70, s70, s34
    s_mov_b32 m0, s69
    s_add_u32 s69, s69, 1024
    buffer_load_dwordx4 v9, s[4:7], s70 offen lds
    s_add_u32 s70, s70, s34
    s_mov_b32 m0, s69
    s_add_u32 s69, s69, 1024
    buffer_load_dwordx4 v9, s[4:7], s70 offen lds
    s_add_u32 s70, s70, s34
    s_mov_b32 m0, s69
    s_add_u32 s69, s69, 1024
    buffer_load_dwordx4 v9, s[4:7], s70 offen lds
    s_add_u32 s70, s70, s34
    s_add_u32 s27, s27, 128
    s_add_u32 s28, s28, s35
    ds_read_b64_tr_b16 v[32:33], v6 offset:32768
    ds_read_b64_tr_b16 v[34:35], v6 offset:33792
    ds_read_b64_tr_b16 v[36:37], v7 offset:32768
    ds_read_b64_tr_b16 v[38:39], v7 offset:33792
    ds_read_b128 v[40:43], v2 offset:32768
    ds_read_b128 v[44:47], v2 offset:36864
    ds_read_b64_tr_b16 v[48:49], v6 offset:36864
    ds_read_b64_tr_b16 v[50:51], v6 offset:37888
    ds_read_b64_tr_b16 v[52:53], v7 offset:36864
    ds_read_b64_tr_b16 v[54:55], v7 offset:37888
    ds_read_b128 v[56:59], v3 offset:32768
    ds_read_b128 v[60:63], v3 offset:36864
    s_waitcnt lgkmcnt(6)
    v_mfma_f32_32x32x16_bf16 v[64:79], v[32:35], v[40:43], v[64:79]
    v_mfma_f32_32x32x16_bf16 v[80:95], v[32:35], v[44:47], v[80:95]
    v_mfma_f32_32x32x16_bf16 v[96:111], v[36:39], v[40:43], v[96:111]
    v_mfma_f32_32x32x16_bf16 v[112:127], v[36:39], v[44:47], v[112:127]
    ds_read_b64_tr_b16 v[32:33], v6 offset:40960
    ds_read_b64_tr_b16 v[34:35], v6 offset:41984
    ds_read_b64_tr_b16 v[36:37], v7 offset:40960
    ds_read_b64_tr_b16 v[38:39], v7 offset:41984
    ds_read_b128 v[40:43], v4 offset:32768
    ds_read_b128 v[44:47], v4 offset:36864
    s_waitcnt lgkmcnt(6)
    v_mfma_f32_32x32x16_bf16 v[64:79], v[48:51], v[56:59], v[64:79]
    v_mfma_f32_32x32x16_bf16 v[80:95], v[48:51], v[60:63], v[80:95]
    v_mfma_f32_32x32x16_bf16 v[96:111], v[52:55], v[56:59], v[96:111]
    v_mfma_f32_32x32x16_bf16 v[112:127], v[52:55], v[60:63], v[112:127]
    ds_read_b64_tr_b16 v[48:49], v6 offset:45056
    ds_read_b64_tr_b16 v[50:51], v6 offset:46080
    ds_read_b64_tr_b16 v[52:53], v7 offset:45056
    ds_read_b64_tr_b16 v[54:55], v7 offset:46080
    ds_read_b128 v[56:59], v5 offset:32768
    ds_read_b128 v[60:63], v5 offset:36864
    s_waitcnt lgkmcnt(6)
    v_mfma_f32_32x32x16_bf16 v[64:79], v[32:35], v[40:43], v[64:79]
    v_mfma_f32_32x32x16_bf16 v[80:95], v[32:35], v[44:47], v[80:95]
    v_mfma_f32_32x32x16_bf16 v[96:111], v[36:39], v[40:43], v[96:111]
    v_mfma_f32_32x32x16_bf16 v[112:127], v[36:39], v[44:47], v[112:127]
    s_waitcnt lgkmcnt(0)
    v_mfma_f32_32x32x16_bf16 v[64:79], v[48:51], v[56:59], v[64:79]
    v_mfma_f32_32x32x16_bf16 v[80:95], v[48:51], v[60:63], v[80:95]
    v_mfma_f32_32x32x16_bf16 v[96:111], v[52:55], v[56:59], v[96:111]
    v_mfma_f32_32x32x16_bf16 v[112:127], v[52:55], v[60:63], v[112:127]
    s_waitcnt vmcnt(0)
    s_barrier
    s_add_u32 s69, s68, 32768
    s_mov_b32 s70, s27
    s_mov_b32 m0, s69
    s_add_u32 s69, s69, 1024
    buffer_load_dwordx4 v8, s[8:11], s70 offen lds
    s_add_u32 s70, s70, 8192
    s_mov_b32 m0, s69
    s_add_u32 s69, s69, 1024
    buffer_load_dwordx4 v8, s[8:11], s70 offen lds
    s_add_u32 s70, s70, 8192
    s_mov_b32 m0, s69
    s_add_u32 s69, s69, 1024
    buffer_load_dwordx4 v8, s[8:11], s70 offen lds
    s_add_u32 s70, s70, 8192
    s_mov_b32 m0, s69
    s_add_u32 s69, s69, 1024
    buffer_load_dwordx4 v8, s[8:11], s70 offen lds
    s_add_u32 s70, s70, 8192
    s_add_u32 s69, s68, 49152
    s_mov_b32 s70, s28
    s_mov_b32 m0, s69
    s_add_u32 s69, s69, 1024
    buffer_load_dwordx4 v9, s[4:7], s70 offen lds
    s_add_u32 s70, s70, s34
    s_mov_b32 m0, s69
    s_add_u32 s69, s69, 1024
    buffer_load_dwordx4 v9, s[4:7], s70 offen lds
    s_add_u32 s70, s70, s34
    s_mov_b32 m0, s69
    s_add_u32 s69, s69, 1024
    buffer_load_dwordx4 v9, s[4:7], s70 offen lds
    s_add_u32 s70, s70, s34
    s_mov_b32 m0, s69
    s_add_u32 s69, s69, 1024
    buffer_load_dwordx4 v9, s[4:7], s70 offen lds
    s_add_u32 s70, s70, s34
    s_add_u32 s27, s27, 128
    s_add_u32 s28, s28, s35
    ds_read_b64_tr_b16 v[32:33], v6 offset:0
    ds_read_b64_tr_b16 v[34:35], v6 offset:1024
    ds_read_b64_tr_b16 v[36:37], v7 offset:0
    ds_read_b64_tr_b16 v[38:39], v7 offset:1024
    ds_read_b128 v[40:43], v2 offset:0
    ds_read_b128 v[44:47], v2 offset:4096
    ds_read_b64_tr_b16 v[48:49], v6 offset:4096
    ds_read_b64_tr_b16 v[50:51], v6 offset:5120
    ds_read_b64_tr_b16 v[52:53], v7 offset:4096
    ds_read_b64_tr_b16 v[54:55], v7 offset:5120
    ds_read_b128 v[56:59], v3 offset:0
    ds_read_b128 v[60:63], v3 offset:4096
    s_waitcnt lgkmcnt(6)
    v_mfma_f32_32x32x16_bf16 v[64:79], v[32:35], v[40:43], v[64:79]
    v_mfma_f32_32x32x16_bf16 v[80:95], v[32:35], v[44:47], v[80:95]
    v_mfma_f32_32x32x16_bf16 v[96:111], v[36:39], v[40:43], v[96:111]
    v_mfma_f32_32x32x16_bf16 v[112:127], v[36:39], v[44:47], v[112:127]
    ds_read_b64_tr_b16 v[32:33], v6 offset:8192
    ds_read_b64_tr_b16 v[34:35], v6 offset:9216
    ds_read_b64_tr_b16 v[36:37], v7 offset:8192
    ds_read_b64_tr_b16 v[38:39], v7 offset:9216
    ds_read_b128 v[40:43], v4 offset:0
    ds_read_b128 v[44:47], v4 offset:4096
    s_waitcnt lgkmcnt(6)
    v_mfma_f32_32x32x16_bf16 v[64:79], v[48:51], v[56:59], v[64:79]
    v_mfma_f32_32x32x16_bf16 v[80:95], v[48:51], v[60:63], v[80:95]
    v_mfma_f32_32x32x16_bf16 v[96:111], v[52:55], v[56:59], v[96:111]
    v_mfma_f32_32x32x16_bf16 v[112:127], v[52:55], v[60:63], v[112:127]
    ds_read_b64_tr_b16 v[48:49], v6 offset:12288
    ds_read_b64_tr_b16 v[50:51], v6 offset:13312
    ds_read_b64_tr_b16 v[52:53], v7 offset:12288
    ds_read_b64_tr_b16 v[54:55], v7 offset:13312
    ds_read_b128 v[56:59], v5 offset:0
    ds_read_b128 v[60:63], v5 offset:4096
    s_waitcnt lgkmcnt(6)
    v_mfma_f32_32x32x16_bf16 v[64:79], v[32:35], v[40:43], v[64:79]
    v_mfma_f32_32x32x16_bf16 v[80:95], v[32:35], v[44:47], v[80:95]
    v_mfma_f32_32x32x16_bf16 v[96:111], v[36:39], v[40:43], v[96:111]
    v_mfma_f32_32x32x16_bf16 v[112:127], v[36:39], v[44:47], v[112:127]
    s_waitcnt lgkmcnt(0)
    v_mfma_f32_32x32x16_bf16 v[64:79], v[48:51], v[56:59], v[64:79]
    v_mfma_f32_32x32x16_bf16 v[80:95], v[48:51], v[60:63], v[80:95]
    v_mfma_f32_32x32x16_bf16 v[96:111], v[52:55], v[56:59], v[96:111]
    v_mfma_f32_32x32x16_bf16 v[112:127], v[52:55], v[60:63], v[112:127]
    s_waitcnt vmcnt(0)
    s_barrier
    ds_read_b64_tr_b16 v[32:33], v6 offset:32768
    ds_read_b64_tr_b16 v[34:35], v6 offset:33792
    ds_read_b64_tr_b16 v[36:37], v7 offset:32768
    ds_read_b64_tr_b16 v[38:39], v7 offset:33792
    ds_read_b128 v[40:43], v2 offset:32768
    ds_read_b128 v[44:47], v2 offset:36864
    ds_read_b64_tr_b16 v[48:49], v6 offset:36864
    ds_read_b64_tr_b16 v[50:51], v6 offset:37888
    ds_read_b64_tr_b16 v[52:53], v7 offset:36864
    ds_read_b64_tr_b16 v[54:55], v7 offset:37888
    ds_read_b128 v[56:59], v3 offset:32768
    ds_read_b128 v[60:63], v3 offset:36864
    s_waitcnt lgkmcnt(6)
    v_mfma_f32_32x32x16_bf16 v[64:79], v[32:35], v[40:43], v[64:79]
    v_mfma_f32_32x32x16_bf16 v[80:95], v[32:35], v[44:47], v[80:95]
    v_mfma_f32_32x32x16_bf16 v[96:111], v[36:39], v[40:43], v[96:111]
    v_mfma_f32_32x32x16_bf16 v[112:127], v[36:39], v[44:47], v[112:127]
    ds_read_b64_tr_b16 v[32:33], v6 offset:40960
    ds_read_b64_tr_b16 v[34:35], v6 offset:41984
    ds_read_b64_tr_b16 v[36:37], v7 offset:40960
    ds_read_b64_tr_b16 v[38:39], v7 offset:41984
    ds_read_b128 v[40:43], v4 offset:32768
    ds_read_b128 v[44:47], v4 offset:36864
    s_waitcnt lgkmcnt(6)
    v_mfma_f32_32x32x16_bf16 v[64:79], v[48:51], v[56:59], v[64:79]
    v_mfma_f32_32x32x16_bf16 v[80:95], v[48:51], v[60:63], v[80:95]
    v_mfma_f32_32x32x16_bf16 v[96:111], v[52:55], v[56:59], v[96:111]
    v_mfma_f32_32x32x16_bf16 v[112:127], v[52:55], v[60:63], v[112:127]
    ds_read_b64_tr_b16 v[48:49], v6 offset:45056
    ds_read_b64_tr_b16 v[50:51], v6 offset:46080
    ds_read_b64_tr_b16 v[52:53], v7 offset:45056
    ds_read_b64_tr_b16 v[54:55], v7 offset:46080
    ds_read_b128 v[56:59], v5 offset:32768
    ds_read_b128 v[60:63], v5 offset:36864
    s_waitcnt lgkmcnt(6)
    v_mfma_f32_32x32x16_bf16 v[64:79], v[32:35], v[40:43], v[64:79]
    v_mfma_f32_32x32x16_bf16 v[80:95], v[32:35], v[44:47], v[80:95]
    v_mfma_f32_32x32x16_bf16 v[96:111], v[36:39], v[40:43], v[96:111]
    v_mfma_f32_32x32x16_bf16 v[112:127], v[36:39], v[44:47], v[112:127]
    s_waitcnt lgkmcnt(0)
    v_mfma_f32_32x32x16_bf16 v[64:79], v[48:51], v[56:59], v[64:79]
    v_mfma_f32_32x32x16_bf16 v[80:95], v[48:51], v[60:63], v[80:95]
    v_mfma_f32_32x32x16_bf16 v[96:111], v[52:55], v[56:59], v[96:111]
    v_mfma_f32_32x32x16_bf16 v[112:127], v[52:55], v[60:63], v[112:127]
    s_branch proj_epi
proj_nt:
    s_add_u32 s69, s68, 32768
    s_mov_b32 s70, s27
    s_mov_b32 m0, s69
    s_add_u32 s69, s69, 1024
    buffer_load_dwordx4 v8, s[8:11], s70 offen lds
    s_add_u32 s70, s70, 8192
    s_mov_b32 m0, s69
    s_add_u32 s69, s69, 1024
    buffer_load_dwordx4 v8, s[8:11], s70 offen lds
    s_add_u32 s70, s70, 8192
    s_mov_b32 m0, s69
    s_add_u32 s69, s69, 1024
    buffer_load_dwordx4 v8, s[8:11], s70 offen lds
    s_add_u32 s70, s70, 8192
    s_mov_b32 m0, s69
    s_add_u32 s69, s69, 1024
    buffer_load_dwordx4 v8, s[8:11], s70 offen lds
    s_add_u32 s70, s70, 8192
    s_add_u32 s69, s68, 49152
    s_mov_b32 s70, s28
    s_mov_b32 m0, s69
    s_add_u32 s69, s69, 1024
    buffer_load_dwordx4 v9, s[4:7], s70 offen lds
    s_add_u32 s70, s70, s34
    s_mov_b32 m0, s69
    s_add_u32 s69, s69, 1024
    buffer_load_dwordx4 v9, s[4:7], s70 offen lds
    s_add_u32 s70, s70, s34
    s_mov_b32 m0, s69
    s_add_u32 s69, s69, 1024
    buffer_load_dwordx4 v9, s[4:7], s70 offen lds
    s_add_u32 s70, s70, s34
    s_mov_b32 m0, s69
    s_add_u32 s69, s69, 1024
    buffer_load_dwordx4 v9, s[4:7], s70 offen lds
    s_add_u32 s70, s70, s34
    s_add_u32 s27, s27, 128
    s_add_u32 s28, s28, s35
    ds_read_b64_tr_b16 v[32:33], v6 offset:0
    ds_read_b64_tr_b16 v[34:35], v6 offset:1024
    ds_read_b64_tr_b16 v[36:37], v7 offset:0
    ds_read_b64_tr_b16 v[38:39], v7 offset:1024
    ds_read_b128 v[40:43], v2 offset:0
    ds_read_b128 v[44:47], v2 offset:4096
    ds_read_b64_tr_b16 v[48:49], v6 offset:4096
    ds_read_b64_tr_b16 v[50:51], v6 offset:5120
    ds_read_b64_tr_b16 v[52:53], v7 offset:4096
    ds_read_b64_tr_b16 v[54:55], v7 offset:5120
    ds_read_b128 v[56:59], v3 offset:0
    ds_read_b128 v[60:63], v3 offset:4096
    s_waitcnt lgkmcnt(6)
    v_mfma_f32_32x32x16_bf16 v[64:79], v[40:43], v[32:35], v[64:79]
    v_mfma_f32_32x32x16_bf16 v[80:95], v[44:47], v[32:35], v[80:95]
    v_mfma_f32_32x32x16_bf16 v[96:111], v[40:43], v[36:39], v[96:111]
    v_mfma_f32_32x32x16_bf16 v[112:127], v[44:47], v[36:39], v[112:127]
    ds_read_b64_tr_b16 v[32:33], v6 offset:8192
    ds_read_b64_tr_b16 v[34:35], v6 offset:9216
    ds_read_b64_tr_b16 v[36:37], v7 offset:8192
    ds_read_b64_tr_b16 v[38:39], v7 offset:9216
    ds_read_b128 v[40:43], v4 offset:0
    ds_read_b128 v[44:47], v4 offset:4096
    s_waitcnt lgkmcnt(6)
    v_mfma_f32_32x32x16_bf16 v[64:79], v[56:59], v[48:51], v[64:79]
    v_mfma_f32_32x32x16_bf16 v[80:95], v[60:63], v[48:51], v[80:95]
    v_mfma_f32_32x32x16_bf16 v[96:111], v[56:59], v[52:55], v[96:111]
    v_mfma_f32_32x32x16_bf16 v[112:127], v[60:63], v[52:55], v[112:127]
    ds_read_b64_tr_b16 v[48:49], v6 offset:12288
    ds_read_b64_tr_b16 v[50:51], v6 offset:13312
    ds_read_b64_tr_b16 v[52:53], v7 offset:12288
    ds_read_b64_tr_b16 v[54:55], v7 offset:13312
    ds_read_b128 v[56:59], v5 offset:0
    ds_read_b128 v[60:63], v5 offset:4096
    s_waitcnt lgkmcnt(6)
    v_mfma_f32_32x32x16_bf16 v[64:79], v[40:43], v[32:35], v[64:79]
    v_mfma_f32_32x32x16_bf16 v[80:95], v[44:47], v[32:35], v[80:95]
    v_mfma_f32_32x32x16_bf16 v[96:111], v[40:43], v[36:39], v[96:111]
    v_mfma_f32_32x32x16_bf16 v[112:127], v[44:47], v[36:39], v[112:127]
    s_waitcnt lgkmcnt(0)
    v_mfma_f32_32x32x16_bf16 v[64:79], v[56:59], v[48:51], v[64:79]
    v_mfma_f32_32x32x16_bf16 v[80:95], v[60:63], v[48:51], v[80:95]
    v_mfma_f32_32x32x16_bf16 v[96:111], v[56:59], v[52:55], v[96:111]
    v_mfma_f32_32x32x16_bf16 v[112:127], v[60:63], v[52:55], v[112:127]
    s_waitcnt vmcnt(0)
    s_barrier
    s_add_u32 s69, s68, 0
    s_mov_b32 s70, s27
    s_mov_b32 m0, s69
    s_add_u32 s69, s69, 1024
    buffer_load_dwordx4 v8, s[8:11], s70 offen lds
    s_add_u32 s70, s70, 8192
    s_mov_b32 m0, s69
    s_add_u32 s69, s69, 1024
    buffer_load_dwordx4 v8, s[8:11], s70 offen lds
    s_add_u32 s70, s70, 8192
    s_mov_b32 m0, s69
    s_add_u32 s69, s69, 1024
    buffer_load_dwordx4 v8, s[8:11], s70 offen lds
    s_add_u32 s70, s70, 8192
    s_mov_b32 m0, s69
    s_add_u32 s69, s69, 1024
    buffer_load_dwordx4 v8, s[8:11], s70 offen lds
    s_add_u32 s70, s70, 8192
    s_add_u32 s69, s68, 16384
    s_mov_b32 s70, s28
    s_mov_b32 m0, s69
    s_add_u32 s69, s69, 1024
    buffer_load_dwordx4 v9, s[4:7], s70 offen lds
    s_add_u32 s70, s70, s34
    s_mov_b32 m0, s69
    s_add_u32 s69, s69, 1024
    buffer_load_dwordx4 v9, s[4:7], s70 offen lds
    s_add_u32 s70, s70, s34
    s_mov_b32 m0, s69
    s_add_u32 s69, s69, 1024
    buffer_load_dwordx4 v9, s[4:7], s70 offen lds
    s_add_u32 s70, s70, s34
    s_mov_b32 m0, s69
    s_add_u32 s69, s69, 1024
    buffer_load_dwordx4 v9, s[4:7], s70 offen lds
    s_add_u32 s70, s70, s34
    s_add_u32 s27, s27, 128
    s_add_u32 s28, s28, s35
    ds_read_b64_tr_b16 v[32:33], v6 offset:32768
    ds_read_b64_tr_b16 v[34:35], v6 offset:33792
    ds_read_b64_tr_b16 v[36:37], v7 offset:32768
    ds_read_b64_tr_b16 v[38:39], v7 offset:33792
    ds_read_b128 v[40:43], v2 offset:32768
    ds_read_b128 v[44:47], v2 offset:36864
    ds_read_b64_tr_b16 v[48:49], v6 offset:36864
    ds_read_b64_tr_b16 v[50:51], v6 offset:37888
    ds_read_b64_tr_b16 v[52:53], v7 offset:36864
    ds_read_b64_tr_b16 v[54:55], v7 offset:37888
    ds_read_b128 v[56:59], v3 offset:32768
    ds_read_b128 v[60:63], v3 offset:36864
    s_waitcnt lgkmcnt(6)
    v_mfma_f32_32x32x16_bf16 v[64:79], v[40:43], v[32:35], v[64:79]
    v_mfma_f32_32x32x16_bf16 v[80:95], v[44:47], v[32:35], v[80:95]
    v_mfma_f32_32x32x16_bf16 v[96:111], v[40:43], v[36:39], v[96:111]
    v_mfma_f32_32x32x16_bf16 v[112:127], v[44:47], v[36:39], v[112:127]
    ds_read_b64_tr_b16 v[32:33], v6 offset:40960
    ds_read_b64_tr_b16 v[34:35], v6 offset:41984
    ds_read_b64_tr_b16 v[36:37], v7 offset:40960
    ds_read_b64_tr_b16 v[38:39], v7 offset:41984
    ds_read_b128 v[40:43], v4 offset:32768
    ds_read_b128 v[44:47], v4 offset:36864
    s_waitcnt lgkmcnt(6)
    v_mfma_f32_32x32x16_bf16 v[64:79], v[56:59], v[48:51], v[64:79]
    v_mfma_f32_32x32x16_bf16 v[80:95], v[60:63], v[48:51], v[80:95]
    v_mfma_f32_32x32x16_bf16 v[96:111], v[56:59], v[52:55], v[96:111]
    v_mfma_f32_32x32x16_bf16 v[112:127], v[60:63], v[52:55], v[112:127]
    ds_read_b64_tr_b16 v[48:49], v6 offset:45056
    ds_read_b64_tr_b16 v[50:51], v6 offset:46080
    ds_read_b64_tr_b16 v[52:53], v7 offset:45056
    ds_read_b64_tr_b16 v[54:55], v7 offset:46080
    ds_read_b128 v[56:59], v5 offset:32768
    ds_read_b128 v[60:63], v5 offset:36864
    s_waitcnt lgkmcnt(6)
    v_mfma_f32_32x32x16_bf16 v[64:79], v[40:43], v[32:35], v[64:79]
    v_mfma_f32_32x32x16_bf16 v[80:95], v[44:47], v[32:35], v[80:95]
    v_mfma_f32_32x32x16_bf16 v[96:111], v[40:43], v[36:39], v[96:111]
    v_mfma_f32_32x32x16_bf16 v[112:127], v[44:47], v[36:39], v[112:127]
    s_waitcnt lgkmcnt(0)
    v_mfma_f32_32x32x16_bf16 v[64:79], v[56:59], v[48:51], v[64:79]
    v_mfma_f32_32x32x16_bf16 v[80:95], v[60:63], v[48:51], v[80:95]
    v_mfma_f32_32x32x16_bf16 v[96:111], v[56:59], v[52:55], v[96:111]
    v_mfma_f32_32x32x16_bf16 v[112:127], v[60:63], v[52:55], v[112:127]
    s_waitcnt vmcnt(0)
    s_barrier
    s_add_u32 s69, s68, 32768
    s_mov_b32 s70, s27
    s_mov_b32 m0, s69
    s_add_u32 s69, s69, 1024
    buffer_load_dwordx4 v8, s[8:11], s70 offen lds
    s_add_u32 s70, s70, 8192
    s_mov_b32 m0, s69
    s_add_u32 s69, s69, 1024
    buffer_load_dwordx4 v8, s[8:11], s70 offen lds
    s_add_u32 s70, s70, 8192
    s_mov_b32 m0, s69
    s_add_u32 s69, s69, 1024
    buffer_load_dwordx4 v8, s[8:11], s70 offen lds
    s_add_u32 s70, s70, 8192
    s_mov_b32 m0, s69
    s_add_u32 s69, s69, 1024
    buffer_load_dwordx4 v8, s[8:11], s70 offen lds
    s_add_u32 s70, s70, 8192
    s_add_u32 s69, s68, 49152
    s_mov_b32 s70, s28
    s_mov_b32 m0, s69
    s_add_u32 s69, s69, 1024
    buffer_load_dwordx4 v9, s[4:7], s70 offen lds
    s_add_u32 s70, s70, s34
    s_mov_b32 m0, s69
    s_add_u32 s69, s69, 1024
    buffer_load_dwordx4 v9, s[4:7], s70 offen lds
    s_add_u32 s70, s70, s34
    s_mov_b32 m0, s69
    s_add_u32 s69, s69, 1024
    buffer_load_dwordx4 v9, s[4:7], s70 offen lds
    s_add_u32 s70, s70, s34
    s_mov_b32 m0, s69
    s_add_u32 s69, s69, 1024
    buffer_load_dwordx4 v9, s[4:7], s70 offen lds
    s_add_u32 s70, s70, s34
    s_add_u32 s27, s27, 128
    s_add_u32 s28, s28, s35
    ds_read_b64_tr_b16 v[32:33], v6 offset:0
    ds_read_b64_tr_b16 v[34:35], v6 offset:1024
    ds_read_b64_tr_b16 v[36:37], v7 offset:0
    ds_read_b64_tr_b16 v[38:39], v7 offset:1024
    ds_read_b128 v[40:43], v2 offset:0
    ds_read_b128 v[44:47], v2 offset:4096
    ds_read_b64_tr_b16 v[48:49], v6 offset:4096
    ds_read_b64_tr_b16 v[50:51], v6 offset:5120
    ds_read_b64_tr_b16 v[52:53], v7 offset:4096
    ds_read_b64_tr_b16 v[54:55], v7 offset:5120
    ds_read_b128 v[56:59], v3 offset:0
    ds_read_b128 v[60:63], v3 offset:4096
    s_waitcnt lgkmcnt(6)
    v_mfma_f32_32x32x16_bf16 v[64:79], v[40:43], v[32:35], v[64:79]
    v_mfma_f32_32x32x16_bf16 v[80:95], v[44:47], v[32:35], v[80:95]
    v_mfma_f32_32x32x16_bf16 v[96:111], v[40:43], v[36:39], v[96:111]
    v_mfma_f32_32x32x16_bf16 v[112:127], v[44:47], v[36:39], v[112:127]
    ds_read_b64_tr_b16 v[32:33], v6 offset:8192
    ds_read_b64_tr_b16 v[34:35], v6 offset:9216
    ds_read_b64_tr_b16 v[36:37], v7 offset:8192
    ds_read_b64_tr_b16 v[38:39], v7 offset:9216
    ds_read_b128 v[40:43], v4 offset:0
    ds_read_b128 v[44:47], v4 offset:4096
    s_waitcnt lgkmcnt(6)
    v_mfma_f32_32x32x16_bf16 v[64:79], v[56:59], v[48:51], v[64:79]
    v_mfma_f32_32x32x16_bf16 v[80:95], v[60:63], v[48:51], v[80:95]
    v_mfma_f32_32x32x16_bf16 v[96:111], v[56:59], v[52:55], v[96:111]
    v_mfma_f32_32x32x16_bf16 v[112:127], v[60:63], v[52:55], v[112:127]
    ds_read_b64_tr_b16 v[48:49], v6 offset:12288
    ds_read_b64_tr_b16 v[50:51], v6 offset:13312
    ds_read_b64_tr_b16 v[52:53], v7 offset:12288
    ds_read_b64_tr_b16 v[54:55], v7 offset:13312
    ds_read_b128 v[56:59], v5 offset:0
    ds_read_b128 v[60:63], v5 offset:4096
    s_waitcnt lgkmcnt(6)
    v_mfma_f32_32x32x16_bf16 v[64:79], v[40:43], v[32:35], v[64:79]
    v_mfma_f32_32x32x16_bf16 v[80:95], v[44:47], v[32:35], v[80:95]
    v_mfma_f32_32x32x16_bf16 v[96:111], v[40:43], v[36:39], v[96:111]
    v_mfma_f32_32x32x16_bf16 v[112:127], v[44:47], v[36:39], v[112:127]
    s_waitcnt lgkmcnt(0)
    v_mfma_f32_32x32x16_bf16 v[64:79], v[56:59], v[48:51], v[64:79]
    v_mfma_f32_32x32x16_bf16 v[80:95], v[60:63], v[48:51], v[80:95]
    v_mfma_f32_32x32x16_bf16 v[96:111], v[56:59], v[52:55], v[96:111]
    v_mfma_f32_32x32x16_bf16 v[112:127], v[60:63], v[52:55], v[112:127]
    s_waitcnt vmcnt(0)
    s_barrier
    s_add_u32 s69, s68, 0
    s_mov_b32 s70, s27
    s_mov_b32 m0, s69
    s_add_u32 s69, s69, 1024
    buffer_load_dwordx4 v8, s[8:11], s70 offen lds
    s_add_u32 s70, s70, 8192
    s_mov_b32 m0, s69
    s_add_u32 s69, s69, 1024
    buffer_load_dwordx4 v8, s[8:11], s70 offen lds
    s_add_u32 s70, s70, 8192
    s_mov_b32 m0, s69
    s_add_u32 s69, s69, 1024
    buffer_load_dwordx4 v8, s[8:11], s70 offen lds
    s_add_u32 s70, s70, 8192
    s_mov_b32 m0, s69
    s_add_u32 s69, s69, 1024
    buffer_load_dwordx4 v8, s[8:11], s70 offen lds
    s_add_u32 s70, s70, 8192
    s_add_u32 s69, s68, 16384
    s_mov_b32 s70, s28
    s_mov_b32 m0, s69
    s_add_u32 s69, s69, 1024
    buffer_load_dwordx4 v9, s[4:7], s70 offen lds
    s_add_u32 s70, s70, s34
    s_mov_b32 m0, s69
    s_add_u32 s69, s69, 1024
    buffer_load_dwordx4 v9, s[4:7], s70 offen lds
    s_add_u32 s70, s70, s34
    s_mov_b32 m0, s69
    s_add_u32 s69, s69, 1024
    buffer_load_dwordx4 v9, s[4:7], s70 offen lds
    s_add_u32 s70, s70, s34
    s_mov_b32 m0, s69
    s_add_u32 s69, s69, 1024
    buffer_load_dwordx4 v9, s[4:7], s70 offen lds
    s_add_u32 s70, s70, s34
    s_add_u32 s27, s27, 128
    s_add_u32 s28, s28, s35
    ds_read_b64_tr_b16 v[32:33], v6 offset:32768
    ds_read_b64_tr_b16 v[34:35], v6 offset:33792
    ds_read_b64_tr_b16 v[36:37], v7 offset:32768
    ds_read_b64_tr_b16 v[38:39], v7 offset:33792
    ds_read_b128 v[40:43], v2 offset:32768
    ds_read_b128 v[44:47], v2 offset:36864
    ds_read_b64_tr_b16 v[48:49], v6 offset:36864
    ds_read_b64_tr_b16 v[50:51], v6 offset:37888
    ds_read_b64_tr_b16 v[52:53], v7 offset:36864
    ds_read_b64_tr_b16 v[54:55], v7 offset:37888
    ds_read_b128 v[56:59], v3 offset:32768
    ds_read_b128 v[60:63], v3 offset:36864
    s_waitcnt lgkmcnt(6)
    v_mfma_f32_32x32x16_bf16 v[64:79], v[40:43], v[32:35], v[64:79]
    v_mfma_f32_32x32x16_bf16 v[80:95], v[44:47], v[32:35], v[80:95]
    v_mfma_f32_32x32x16_bf16 v[96:111], v[40:43], v[36:39], v[96:111]
    v_mfma_f32_32x32x16_bf16 v[112:127], v[44:47], v[36:39], v[112:127]
    ds_read_b64_tr_b16 v[32:33], v6 offset:40960
    ds_read_b64_tr_b16 v[34:35], v6 offset:41984
    ds_read_b64_tr_b16 v[36:37], v7 offset:40960
    ds_read_b64_tr_b16 v[38:39], v7 offset:41984
    ds_read_b128 v[40:43], v4 offset:32768
    ds_read_b128 v[44:47], v4 offset:36864
    s_waitcnt lgkmcnt(6)
    v_mfma_f32_32x32x16_bf16 v[64:79], v[56:59], v[48:51], v[64:79]
    v_mfma_f32_32x32x16_bf16 v[80:95], v[60:63], v[48:51], v[80:95]
    v_mfma_f32_32x32x16_bf16 v[96:111], v[56:59], v[52:55], v[96:111]
    v_mfma_f32_32x32x16_bf16 v[112:127], v[60:63], v[52:55], v[112:127]
    ds_read_b64_tr_b16 v[48:49], v6 offset:45056
    ds_read_b64_tr_b16 v[50:51], v6 offset:46080
    ds_read_b64_tr_b16 v[52:53], v7 offset:45056
    ds_read_b64_tr_b16 v[54:55], v7 offset:46080
    ds_read_b128 v[56:59], v5 offset:32768
    ds_read_b128 v[60:63], v5 offset:36864
    s_waitcnt lgkmcnt(6)
    v_mfma_f32_32x32x16_bf16 v[64:79], v[40:43], v[32:35], v[64:79]
    v_mfma_f32_32x32x16_bf16 v[80:95], v[44:47], v[32:35], v[80:95]
    v_mfma_f32_32x32x16_bf16 v[96:111], v[40:43], v[36:39], v[96:111]
    v_mfma_f32_32x32x16_bf16 v[112:127], v[44:47], v[36:39], v[112:127]
    s_waitcnt lgkmcnt(0)
    v_mfma_f32_32x32x16_bf16 v[64:79], v[56:59], v[48:51], v[64:79]
    v_mfma_f32_32x32x16_bf16 v[80:95], v[60:63], v[48:51], v[80:95]
    v_mfma_f32_32x32x16_bf16 v[96:111], v[56:59], v[52:55], v[96:111]
    v_mfma_f32_32x32x16_bf16 v[112:127], v[60:63], v[52:55], v[112:127]
    s_waitcnt vmcnt(0)
    s_barrier
    s_add_u32 s69, s68, 32768
    s_mov_b32 s70, s27
    s_mov_b32 m0, s69
    s_add_u32 s69, s69, 1024
    buffer_load_dwordx4 v8, s[8:11], s70 offen lds
    s_add_u32 s70, s70, 8192
    s_mov_b32 m0, s69
    s_add_u32 s69, s69, 1024
    buffer_load_dwordx4 v8, s[8:11], s70 offen lds
    s_add_u32 s70, s70, 8192
    s_mov_b32 m0, s69
    s_add_u32 s69, s69, 1024
    buffer_load_dwordx4 v8, s[8:11], s70 offen lds
    s_add_u32 s70, s70, 8192
    s_mov_b32 m0, s69
    s_add_u32 s69, s69, 1024
    buffer_load_dwordx4 v8, s[8:11], s70 offen lds
    s_add_u32 s70, s70, 8192
    s_add_u32 s69, s68, 49152
    s_mov_b32 s70, s28
    s_mov_b32 m0, s69
    s_add_u32 s69, s69, 1024
    buffer_load_dwordx4 v9, s[4:7], s70 offen lds
    s_add_u32 s70, s70, s34
    s_mov_b32 m0, s69
    s_add_u32 s69, s69, 1024
    buffer_load_dwordx4 v9, s[4:7], s70 offen lds
    s_add_u32 s70, s70, s34
    s_mov_b32 m0, s69
    s_add_u32 s69, s69, 1024
    buffer_load_dwordx4 v9, s[4:7], s70 offen lds
    s_add_u32 s70, s70, s34
    s_mov_b32 m0, s69
    s_add_u32 s69, s69, 1024
    buffer_load_dwordx4 v9, s[4:7], s70 offen lds
    s_add_u32 s70, s70, s34
    s_add_u32 s27, s27, 128
    s_add_u32 s28, s28, s35
    ds_read_b64_tr_b16 v[32:33], v6 offset:0
    ds_read_b64_tr_b16 v[34:35], v6 offset:1024
    ds_read_b64_tr_b16 v[36:37], v7 offset:0
    ds_read_b64_tr_b16 v[38:39], v7 offset:1024
    ds_read_b128 v[40:43], v2 offset:0
    ds_read_b128 v[44:47], v2 offset:4096
    ds_read_b64_tr_b16 v[48:49], v6 offset:4096
    ds_read_b64_tr_b16 v[50:51], v6 offset:5120
    ds_read_b64_tr_b16 v[52:53], v7 offset:4096
    ds_read_b64_tr_b16 v[54:55], v7 offset:5120
    ds_read_b128 v[56:59], v3 offset:0
    ds_read_b128 v[60:63], v3 offset:4096
    s_waitcnt lgkmcnt(6)
    v_mfma_f32_32x32x16_bf16 v[64:79], v[40:43], v[32:35], v[64:79]
    v_mfma_f32_32x32x16_bf16 v[80:95], v[44:47], v[32:35], v[80:95]
    v_mfma_f32_32x32x16_bf16 v[96:111], v[40:43], v[36:39], v[96:111]
    v_mfma_f32_32x32x16_bf16 v[112:127], v[44:47], v[36:39], v[112:127]
    ds_read_b64_tr_b16 v[32:33], v6 offset:8192
    ds_read_b64_tr_b16 v[34:35], v6 offset:9216
    ds_read_b64_tr_b16 v[36:37], v7 offset:8192
    ds_read_b64_tr_b16 v[38:39], v7 offset:9216
    ds_read_b128 v[40:43], v4 offset:0
    ds_read_b128 v[44:47], v4 offset:4096
    s_waitcnt lgkmcnt(6)
    v_mfma_f32_32x32x16_bf16 v[64:79], v[56:59], v[48:51], v[64:79]
    v_mfma_f32_32x32x16_bf16 v[80:95], v[60:63], v[48:51], v[80:95]
    v_mfma_f32_32x32x16_bf16 v[96:111], v[56:59], v[52:55], v[96:111]
    v_mfma_f32_32x32x16_bf16 v[112:127], v[60:63], v[52:55], v[112:127]
    ds_read_b64_tr_b16 v[48:49], v6 offset:12288
    ds_read_b64_tr_b16 v[50:51], v6 offset:13312
    ds_read_b64_tr_b16 v[52:53], v7 offset:12288
    ds_read_b64_tr_b16 v[54:55], v7 offset:13312
    ds_read_b128 v[56:59], v5 offset:0
    ds_read_b128 v[60:63], v5 offset:4096
    s_waitcnt lgkmcnt(6)
    v_mfma_f32_32x32x16_bf16 v[64:79], v[40:43], v[32:35], v[64:79]
    v_mfma_f32_32x32x16_bf16 v[80:95], v[44:47], v[32:35], v[80:95]
    v_mfma_f32_32x32x16_bf16 v[96:111], v[40:43], v[36:39], v[96:111]
    v_mfma_f32_32x32x16_bf16 v[112:127], v[44:47], v[36:39], v[112:127]
    s_waitcnt lgkmcnt(0)
    v_mfma_f32_32x32x16_bf16 v[64:79], v[56:59], v[48:51], v[64:79]
    v_mfma_f32_32x32x16_bf16 v[80:95], v[60:63], v[48:51], v[80:95]
    v_mfma_f32_32x32x16_bf16 v[96:111], v[56:59], v[52:55], v[96:111]
    v_mfma_f32_32x32x16_bf16 v[112:127], v[60:63], v[52:55], v[112:127]
    s_waitcnt vmcnt(0)
    s_barrier
    s_add_u32 s69, s68, 0
    s_mov_b32 s70, s27
    s_mov_b32 m0, s69
    s_add_u32 s69, s69, 1024
    buffer_load_dwordx4 v8, s[8:11], s70 offen lds
    s_add_u32 s70, s70, 8192
    s_mov_b32 m0, s69
    s_add_u32 s69, s69, 1024
    buffer_load_dwordx4 v8, s[8:11], s70 offen lds
    s_add_u32 s70, s70, 8192
    s_mov_b32 m0, s69
    s_add_u32 s69, s69, 1024
    buffer_load_dwordx4 v8, s[8:11], s70 offen lds
    s_add_u32 s70, s70, 8192
    s_mov_b32 m0, s69
    s_add_u32 s69, s69, 1024
    buffer_load_dwordx4 v8, s[8:11], s70 offen lds
    s_add_u32 s70, s70, 8192
    s_add_u32 s69, s68, 16384
    s_mov_b32 s70, s28
    s_mov_b32 m0, s69
    s_add_u32 s69, s69, 1024
    buffer_load_dwordx4 v9, s[4:7], s70 offen lds
    s_add_u32 s70, s70, s34
    s_mov_b32 m0, s69
    s_add_u32 s69, s69, 1024
    buffer_load_dwordx4 v9, s[4:7], s70 offen lds
    s_add_u32 s70, s70, s34
    s_mov_b32 m0, s69
    s_add_u32 s69, s69, 1024
    buffer_load_dwordx4 v9, s[4:7], s70 offen lds
    s_add_u32 s70, s70, s34
    s_mov_b32 m0, s69
    s_add_u32 s69, s69, 1024
    buffer_load_dwordx4 v9, s[4:7], s70 offen lds
    s_add_u32 s70, s70, s34
    s_add_u32 s27, s27, 128
    s_add_u32 s28, s28, s35
    ds_read_b64_tr_b16 v[32:33], v6 offset:32768
    ds_read_b64_tr_b16 v[34:35], v6 offset:33792
    ds_read_b64_tr_b16 v[36:37], v7 offset:32768
    ds_read_b64_tr_b16 v[38:39], v7 offset:33792
    ds_read_b128 v[40:43], v2 offset:32768
    ds_read_b128 v[44:47], v2 offset:36864
    ds_read_b64_tr_b16 v[48:49], v6 offset:36864
    ds_read_b64_tr_b16 v[50:51], v6 offset:37888
    ds_read_b64_tr_b16 v[52:53], v7 offset:36864
    ds_read_b64_tr_b16 v[54:55], v7 offset:37888
    ds_read_b128 v[56:59], v3 offset:32768
    ds_read_b128 v[60:63], v3 offset:36864
    s_waitcnt lgkmcnt(6)
    v_mfma_f32_32x32x16_bf16 v[64:79], v[40:43], v[32:35], v[64:79]
    v_mfma_f32_32x32x16_bf16 v[80:95], v[44:47], v[32:35], v[80:95]
    v_mfma_f32_32x32x16_bf16 v[96:111], v[40:43], v[36:39], v[96:111]
    v_mfma_f32_32x32x16_bf16 v[112:127], v[44:47], v[36:39], v[112:127]
    ds_read_b64_tr_b16 v[32:33], v6 offset:40960
    ds_read_b64_tr_b16 v[34:35], v6 offset:41984
    ds_read_b64_tr_b16 v[36:37], v7 offset:40960
    ds_read_b64_tr_b16 v[38:39], v7 offset:41984
    ds_read_b128 v[40:43], v4 offset:32768
    ds_read_b128 v[44:47], v4 offset:36864
    s_waitcnt lgkmcnt(6)
    v_mfma_f32_32x32x16_bf16 v[64:79], v[56:59], v[48:51], v[64:79]
    v_mfma_f32_32x32x16_bf16 v[80:95], v[60:63], v[48:51], v[80:95]
    v_mfma_f32_32x32x16_bf16 v[96:111], v[56:59], v[52:55], v[96:111]
    v_mfma_f32_32x32x16_bf16 v[112:127], v[60:63], v[52:55], v[112:127]
    ds_read_b64_tr_b16 v[48:49], v6 offset:45056
    ds_read_b64_tr_b16 v[50:51], v6 offset:46080
    ds_read_b64_tr_b16 v[52:53], v7 offset:45056
    ds_read_b64_tr_b16 v[54:55], v7 offset:46080
    ds_read_b128 v[56:59], v5 offset:32768
    ds_read_b128 v[60:63], v5 offset:36864
    s_waitcnt lgkmcnt(6)
    v_mfma_f32_32x32x16_bf16 v[64:79], v[40:43], v[32:35], v[64:79]
    v_mfma_f32_32x32x16_bf16 v[80:95], v[44:47], v[32:35], v[80:95]
    v_mfma_f32_32x32x16_bf16 v[96:111], v[40:43], v[36:39], v[96:111]
    v_mfma_f32_32x32x16_bf16 v[112:127], v[44:47], v[36:39], v[112:127]
    s_waitcnt lgkmcnt(0)
    v_mfma_f32_32x32x16_bf16 v[64:79], v[56:59], v[48:51], v[64:79]
    v_mfma_f32_32x32x16_bf16 v[80:95], v[60:63], v[48:51], v[80:95]
    v_mfma_f32_32x32x16_bf16 v[96:111], v[56:59], v[52:55], v[96:111]
    v_mfma_f32_32x32x16_bf16 v[112:127], v[60:63], v[52:55], v[112:127]
    s_waitcnt vmcnt(0)
    s_barrier
    s_add_u32 s69, s68, 32768
    s_mov_b32 s70, s27
    s_mov_b32 m0, s69
    s_add_u32 s69, s69, 1024
    buffer_load_dwordx4 v8, s[8:11], s70 offen lds
    s_add_u32 s70, s70, 8192
    s_mov_b32 m0, s69
    s_add_u32 s69, s69, 1024
    buffer_load_dwordx4 v8, s[8:11], s70 offen lds
    s_add_u32 s70, s70, 8192
    s_mov_b32 m0, s69
    s_add_u32 s69, s69, 1024
    buffer_load_dwordx4 v8, s[8:11], s70 offen lds
    s_add_u32 s70, s70, 8192
    s_mov_b32 m0, s69
    s_add_u32 s69, s69, 1024
    buffer_load_dwordx4 v8, s[8:11], s70 offen lds
    s_add_u32 s70, s70, 8192
    s_add_u32 s69, s68, 49152
    s_mov_b32 s70, s28
    s_mov_b32 m0, s69
    s_add_u32 s69, s69, 1024
    buffer_load_dwordx4 v9, s[4:7], s70 offen lds
    s_add_u32 s70, s70, s34
    s_mov_b32 m0, s69
    s_add_u32 s69, s69, 1024
    buffer_load_dwordx4 v9, s[4:7], s70 offen lds
    s_add_u32 s70, s70, s34
    s_mov_b32 m0, s69
    s_add_u32 s69, s69, 1024
    buffer_load_dwordx4 v9, s[4:7], s70 offen lds
    s_add_u32 s70, s70, s34
    s_mov_b32 m0, s69
    s_add_u32 s69, s69, 1024
    buffer_load_dwordx4 v9, s[4:7], s70 offen lds
    s_add_u32 s70, s70, s34
    s_add_u32 s27, s27, 128
    s_add_u32 s28, s28, s35
    ds_read_b64_tr_b16 v[32:33], v6 offset:0
    ds_read_b64_tr_b16 v[34:35], v6 offset:1024
    ds_read_b64_tr_b16 v[36:37], v7 offset:0
    ds_read_b64_tr_b16 v[38:39], v7 offset:1024
    ds_read_b128 v[40:43], v2 offset:0
    ds_read_b128 v[44:47], v2 offset:4096
    ds_read_b64_tr_b16 v[48:49], v6 offset:4096
    ds_read_b64_tr_b16 v[50:51], v6 offset:5120
    ds_read_b64_tr_b16 v[52:53], v7 offset:4096
    ds_read_b64_tr_b16 v[54:55], v7 offset:5120
    ds_read_b128 v[56:59], v3 offset:0
    ds_read_b128 v[60:63], v3 offset:4096
    s_waitcnt lgkmcnt(6)
    v_mfma_f32_32x32x16_bf16 v[64:79], v[40:43], v[32:35], v[64:79]
    v_mfma_f32_32x32x16_bf16 v[80:95], v[44:47], v[32:35], v[80:95]
    v_mfma_f32_32x32x16_bf16 v[96:111], v[40:43], v[36:39], v[96:111]
    v_mfma_f32_32x32x16_bf16 v[112:127], v[44:47], v[36:39], v[112:127]
    ds_read_b64_tr_b16 v[32:33], v6 offset:8192
    ds_read_b64_tr_b16 v[34:35], v6 offset:9216
    ds_read_b64_tr_b16 v[36:37], v7 offset:8192
    ds_read_b64_tr_b16 v[38:39], v7 offset:9216
    ds_read_b128 v[40:43], v4 offset:0
    ds_read_b128 v[44:47], v4 offset:4096
    s_waitcnt lgkmcnt(6)
    v_mfma_f32_32x32x16_bf16 v[64:79], v[56:59], v[48:51], v[64:79]
    v_mfma_f32_32x32x16_bf16 v[80:95], v[60:63], v[48:51], v[80:95]
    v_mfma_f32_32x32x16_bf16 v[96:111], v[56:59], v[52:55], v[96:111]
    v_mfma_f32_32x32x16_bf16 v[112:127], v[60:63], v[52:55], v[112:127]
    ds_read_b64_tr_b16 v[48:49], v6 offset:12288
    ds_read_b64_tr_b16 v[50:51], v6 offset:13312
    ds_read_b64_tr_b16 v[52:53], v7 offset:12288
    ds_read_b64_tr_b16 v[54:55], v7 offset:13312
    ds_read_b128 v[56:59], v5 offset:0
    ds_read_b128 v[60:63], v5 offset:4096
    s_waitcnt lgkmcnt(6)
    v_mfma_f32_32x32x16_bf16 v[64:79], v[40:43], v[32:35], v[64:79]
    v_mfma_f32_32x32x16_bf16 v[80:95], v[44:47], v[32:35], v[80:95]
    v_mfma_f32_32x32x16_bf16 v[96:111], v[40:43], v[36:39], v[96:111]
    v_mfma_f32_32x32x16_bf16 v[112:127], v[44:47], v[36:39], v[112:127]
    s_waitcnt lgkmcnt(0)
    v_mfma_f32_32x32x16_bf16 v[64:79], v[56:59], v[48:51], v[64:79]
    v_mfma_f32_32x32x16_bf16 v[80:95], v[60:63], v[48:51], v[80:95]
    v_mfma_f32_32x32x16_bf16 v[96:111], v[56:59], v[52:55], v[96:111]
    v_mfma_f32_32x32x16_bf16 v[112:127], v[60:63], v[52:55], v[112:127]
    s_waitcnt vmcnt(0)
    s_barrier
    ds_read_b64_tr_b16 v[32:33], v6 offset:32768
    ds_read_b64_tr_b16 v[34:35], v6 offset:33792
    ds_read_b64_tr_b16 v[36:37], v7 offset:32768
    ds_read_b64_tr_b16 v[38:39], v7 offset:33792
    ds_read_b128 v[40:43], v2 offset:32768
    ds_read_b128 v[44:47], v2 offset:36864
    ds_read_b64_tr_b16 v[48:49], v6 offset:36864
    ds_read_b64_tr_b16 v[50:51], v6 offset:37888
    ds_read_b64_tr_b16 v[52:53], v7 offset:36864
    ds_read_b64_tr_b16 v[54:55], v7 offset:37888
    ds_read_b128 v[56:59], v3 offset:32768
    ds_read_b128 v[60:63], v3 offset:36864
    s_waitcnt lgkmcnt(6)
    v_mfma_f32_32x32x16_bf16 v[64:79], v[40:43], v[32:35], v[64:79]
    v_mfma_f32_32x32x16_bf16 v[80:95], v[44:47], v[32:35], v[80:95]
    v_mfma_f32_32x32x16_bf16 v[96:111], v[40:43], v[36:39], v[96:111]
    v_mfma_f32_32x32x16_bf16 v[112:127], v[44:47], v[36:39], v[112:127]
    ds_read_b64_tr_b16 v[32:33], v6 offset:40960
    ds_read_b64_tr_b16 v[34:35], v6 offset:41984
    ds_read_b64_tr_b16 v[36:37], v7 offset:40960
    ds_read_b64_tr_b16 v[38:39], v7 offset:41984
    ds_read_b128 v[40:43], v4 offset:32768
    ds_read_b128 v[44:47], v4 offset:36864
    s_waitcnt lgkmcnt(6)
    v_mfma_f32_32x32x16_bf16 v[64:79], v[56:59], v[48:51], v[64:79]
    v_mfma_f32_32x32x16_bf16 v[80:95], v[60:63], v[48:51], v[80:95]
    v_mfma_f32_32x32x16_bf16 v[96:111], v[56:59], v[52:55], v[96:111]
    v_mfma_f32_32x32x16_bf16 v[112:127], v[60:63], v[52:55], v[112:127]
    ds_read_b64_tr_b16 v[48:49], v6 offset:45056
    ds_read_b64_tr_b16 v[50:51], v6 offset:46080
    ds_read_b64_tr_b16 v[52:53], v7 offset:45056
    ds_read_b64_tr_b16 v[54:55], v7 offset:46080
    ds_read_b128 v[56:59], v5 offset:32768
    ds_read_b128 v[60:63], v5 offset:36864
    s_waitcnt lgkmcnt(6)
    v_mfma_f32_32x32x16_bf16 v[64:79], v[40:43], v[32:35], v[64:79]
    v_mfma_f32_32x32x16_bf16 v[80:95], v[44:47], v[32:35], v[80:95]
    v_mfma_f32_32x32x16_bf16 v[96:111], v[40:43], v[36:39], v[96:111]
    v_mfma_f32_32x32x16_bf16 v[112:127], v[44:47], v[36:39], v[112:127]
    s_waitcnt lgkmcnt(0)
    v_mfma_f32_32x32x16_bf16 v[64:79], v[56:59], v[48:51], v[64:79]
    v_mfma_f32_32x32x16_bf16 v[80:95], v[60:63], v[48:51], v[80:95]
    v_mfma_f32_32x32x16_bf16 v[96:111], v[56:59], v[52:55], v[96:111]
    v_mfma_f32_32x32x16_bf16 v[112:127], v[60:63], v[52:55], v[112:127]
proj_epi:
    s_nop 7
    s_nop 7
    s_lshl_b32 s30, s32, 2
    s_lshl_b32 s69, s18, 1
    s_add_u32 s30, s30, s69
    s_mul_i32 s30, s30, s24
    s_add_u32 s23, s23, s30
    s_lshl_b32 s69, s17, 1
    s_mul_i32 s69, s69, s25
    s_add_u32 s23, s23, s69
    s_mul_i32 s70, s24, 0
    s_add_u32 s70, s70, s23
    s_cmp_eq_u32 s29, 2
    s_cbranch_scc1 proj_sk_000_go
    s_cmp_lg_u32 s17, 0
    s_cbranch_scc1 proj_sk_000
proj_sk_000_go:
    v_cvt_pk_bf16_f32 v32, v64, v65
    v_cvt_pk_bf16_f32 v33, v66, v67
    v_cvt_pk_bf16_f32 v34, v68, v69
    v_cvt_pk_bf16_f32 v35, v70, v71
    buffer_store_dwordx4 v[32:35], v10, s[12:15], s70 offen
    s_nop 1
proj_sk_000:
    s_mul_i32 s70, s24, 0
    s_add_u32 s70, s70, s23
    s_add_u32 s70, s70, s26
    s_cmp_eq_u32 s29, 2
    s_cbranch_scc1 proj_sk_001_go
    s_cmp_lg_u32 s17, 0
    s_cbranch_scc1 proj_sk_001
    s_cmp_eq_u32 s29, 1
    s_cbranch_scc1 proj_sk_001
proj_sk_001_go:
    v_cvt_pk_bf16_f32 v32, v72, v73
    v_cvt_pk_bf16_f32 v33, v74, v75
    v_cvt_pk_bf16_f32 v34, v76, v77
    v_cvt_pk_bf16_f32 v35, v78, v79
    buffer_store_dwordx4 v[32:35], v10, s[12:15], s70 offen
    s_nop 1
proj_sk_001:
    s_mul_i32 s70, s24, 1
    s_add_u32 s70, s70, s23
    s_cmp_eq_u32 s29, 2
    s_cbranch_scc1 proj_sk_010_go
    s_cmp_lg_u32 s17, 0
    s_cbranch_scc1 proj_sk_010
proj_sk_010_go:
    v_cvt_pk_bf16_f32 v32, v80, v81
    v_cvt_pk_bf16_f32 v33, v82, v83
    v_cvt_pk_bf16_f32 v34, v84, v85
    v_cvt_pk_bf16_f32 v35, v86, v87
    buffer_store_dwordx4 v[32:35], v10, s[12:15], s70 offen
    s_nop 1
proj_sk_010:
    s_mul_i32 s70, s24, 1
    s_add_u32 s70, s70, s23
    s_add_u32 s70, s70, s26
    s_cmp_eq_u32 s29, 2
    s_cbranch_scc1 proj_sk_011_go
    s_cmp_lg_u32 s17, 0
    s_cbranch_scc1 proj_sk_011
    s_cmp_eq_u32 s29, 1
    s_cbranch_scc1 proj_sk_011
proj_sk_011_go:
    v_cvt_pk_bf16_f32 v32, v88, v89
    v_cvt_pk_bf16_f32 v33, v90, v91
    v_cvt_pk_bf16_f32 v34, v92, v93
    v_cvt_pk_bf16_f32 v35, v94, v95
    buffer_store_dwordx4 v[32:35], v10, s[12:15], s70 offen
    s_nop 1
proj_sk_011:
    s_mul_i32 s70, s24, 0
    s_add_u32 s70, s70, s23
    s_add_u32 s70, s70, s25
    s_cmp_lg_u32 s29, 2
    s_cbranch_scc1 proj_sk_100
    v_cvt_pk_bf16_f32 v32, v96, v97
    v_cvt_pk_bf16_f32 v33, v98, v99
    v_cvt_pk_bf16_f32 v34, v100, v101
    v_cvt_pk_bf16_f32 v35, v102, v103
    buffer_store_dwordx4 v[32:35], v10, s[12:15], s70 offen
    s_nop 1
proj_sk_100:
    s_mul_i32 s70, s24, 0
    s_add_u32 s70, s70, s23
    s_add_u32 s70, s70, s25
    s_add_u32 s70, s70, s26
    s_cmp_lg_u32 s29, 2
    s_cbranch_scc1 proj_sk_101
    v_cvt_pk_bf16_f32 v32, v104, v105
    v_cvt_pk_bf16_f32 v33, v106, v107
    v_cvt_pk_bf16_f32 v34, v108, v109
    v_cvt_pk_bf16_f32 v35, v110, v111
    buffer_store_dwordx4 v[32:35], v10, s[12:15], s70 offen
    s_nop 1
proj_sk_101:
    s_mul_i32 s70, s24, 1
    s_add_u32 s70, s70, s23
    s_add_u32 s70, s70, s25
    s_cmp_lg_u32 s29, 2
    s_cbranch_scc1 proj_sk_110
    v_cvt_pk_bf16_f32 v32, v112, v113
    v_cvt_pk_bf16_f32 v33, v114, v115
    v_cvt_pk_bf16_f32 v34, v116, v117
    v_cvt_pk_bf16_f32 v35, v118, v119
    buffer_store_dwordx4 v[32:35], v10, s[12:15], s70 offen
    s_nop 1
proj_sk_110:
    s_mul_i32 s70, s24, 1
    s_add_u32 s70, s70, s23
    s_add_u32 s70, s70, s25
    s_add_u32 s70, s70, s26
    s_cmp_lg_u32 s29, 2
    s_cbranch_scc1 proj_sk_111
    v_cvt_pk_bf16_f32 v32, v120, v121
    v_cvt_pk_bf16_f32 v33, v122, v123
    v_cvt_pk_bf16_f32 v34, v124, v125
    v_cvt_pk_bf16_f32 v35, v126, v127
    buffer_store_dwordx4 v[32:35], v10, s[12:15], s70 offen
    s_nop 1
proj_sk_111:
proj_exit:
    s_endpgm
.section .rodata,"a"
.p2align 6
.amdhsa_kernel proj_kernel
  .amdhsa_next_free_vgpr 128
  .amdhsa_next_free_sgpr 102
  .amdhsa_accum_offset 128
  .amdhsa_group_segment_fixed_size 0
  .amdhsa_kernarg_size 112
  .amdhsa_user_sgpr_count 2
  .amdhsa_user_sgpr_kernarg_segment_ptr 1
  .amdhsa_system_sgpr_workgroup_id_x 1
.end_amdhsa_kernel
.text

.globl attnb_kernel
.p2align 8
.type attnb_kernel,@function
attnb_kernel:
    s_cmp_ge_u32 s2, 256
    s_cbranch_scc1 attna_entry
    s_load_dwordx2 s[4:5], s[0:1], 104
    v_lshrrev_b32 v1, 6, v0
    v_and_b32 v0, 63, v0
    s_nop 0
    v_readfirstlane_b32 s16, v1
    s_waitcnt lgkmcnt(0)
    s_mov_b32 s8, s4
    s_and_b32 s9, s5, 0xffff
    s_mov_b32 s10, 268435456
    s_mov_b32 s11, 0x00020000
    s_and_b32 s17, s2, 7
    s_lshl_b32 s17, s17, 2
    s_lshr_b32 s18, s2, 3
    s_and_b32 s18, s18, 3
    s_add_u32 s17, s17, s18
    s_lshr_b32 s18, s2, 5
    v_lshlrev_b32 v8, 4, v0
    s_mov_b32 s40, 0x3e0293ee
    s_mov_b32 s19, 0
attnb_pass:
    s_sub_u32 s20, 15, s18
    s_cmp_eq_u32 s19, 0
    s_cselect_b32 s20, s20, s18
    s_lshl_b32 s21, s20, 1
    s_add_u32 s21, s21, 2
    s_lshl_b32 s22, s17, 6
    s_lshl_b32 s23, s20, 2
    s_add_u32 s22, s22, s23
    s_add_u32 s22, s22, s16
    s_lshl_b32 s22, s22, 13
    s_add_u32 s22, s22, 0
    s_add_u32 s23, s22, 4096
    buffer_load_dwordx4 v[16:19], v8, s[8:11], s22 offen offset:0
    buffer_load_dwordx4 v[20:23], v8, s[8:11], s22 offen offset:1024
    buffer_load_dwordx4 v[24:27], v8, s[8:11], s22 offen offset:2048
    buffer_load_dwordx4 v[28:31], v8, s[8:11], s22 offen offset:3072
    buffer_load_dwordx4 v[32:35], v8, s[8:11], s23 offen offset:0
    buffer_load_dwordx4 v[36:39], v8, s[8:11], s23 offen offset:1024
    buffer_load_dwordx4 v[40:43], v8, s[8:11], s23 offen offset:2048
    buffer_load_dwordx4 v[44:47], v8, s[8:11], s23 offen offset:3072
    s_lshl_b32 s24, s17, 19
    s_lshl_b32 s25, s16, 12
    s_add_u32 s24, s24, s25
    s_add_u32 s25, s24, 33554432
    s_add_u32 s24, s24, 16777216
    v_and_b32 v7, 31, v0
    v_lshrrev_b32 v10, 5, v0
    v_lshlrev_b32 v10, 2, v10
    v_sub_u32 v7, v7, v10
    s_lshl_b32 s26, s20, 7
    s_lshl_b32 s27, s16, 5
    s_add_u32 s26, s26, s27
    v_add_u32 v7, s26, v7
    v_mov_b32 v2, 0xf149f2ca
    v_mov_b32 v3, 0
    v_mov_b32 v96, 0
    v_mov_b32 v97, 0
    v_mov_b32 v98, 0
    v_mov_b32 v99, 0
    v_mov_b32 v100, 0
    v_mov_b32 v101, 0
    v_mov_b32 v102, 0
    v_mov_b32 v103, 0
    v_mov_b32 v104, 0
    v_mov_b32 v105, 0
    v_mov_b32 v106, 0
    v_mov_b32 v107, 0
    v_mov_b32 v108, 0
    v_mov_b32 v109, 0
    v_mov_b32 v110, 0
    v_mov_b32 v111, 0
    v_mov_b32 v112, 0
    v_mov_b32 v113, 0
    v_mov_b32 v114, 0
    v_mov_b32 v115, 0
    v_mov_b32 v116, 0
    v_mov_b32 v117, 0
    v_mov_b32 v118, 0
    v_mov_b32 v119, 0
    v_mov_b32 v120, 0
    v_mov_b32 v121, 0
    v_mov_b32 v122, 0
    v_mov_b32 v123, 0
    v_mov_b32 v124, 0
    v_mov_b32 v125, 0
    v_mov_b32 v126, 0
    v_mov_b32 v127, 0
    v_mov_b32 v128, 0
    v_mov_b32 v129, 0
    v_mov_b32 v130, 0
    v_mov_b32 v131, 0
    v_mov_b32 v132, 0
    v_mov_b32 v133, 0
    v_mov_b32 v134, 0
    v_mov_b32 v135, 0
    v_mov_b32 v136, 0
    v_mov_b32 v137, 0
    v_mov_b32 v138, 0
    v_mov_b32 v139, 0
    v_mov_b32 v140, 0
    v_mov_b32 v141, 0
    v_mov_b32 v142, 0
    v_mov_b32 v143, 0
    v_mov_b32 v144, 0
    v_mov_b32 v145, 0
    v_mov_b32 v146, 0
    v_mov_b32 v147, 0
    v_mov_b32 v148, 0
    v_mov_b32 v149, 0
    v_mov_b32 v150, 0
    v_mov_b32 v151, 0
    v_mov_b32 v152, 0
    v_mov_b32 v153, 0
    v_mov_b32 v154, 0
    v_mov_b32 v155, 0
    v_mov_b32 v156, 0
    v_mov_b32 v157, 0
    v_mov_b32 v158, 0
    v_mov_b32 v159, 0
    s_lshl_b32 s28, s16, 12
    s_mov_b32 s44, 0
    s_mov_b32 s45, 16384
    s_barrier
    s_add_u32 s30, s28, s44
    s_mov_b32 m0, s30
    s_nop 0
    buffer_load_dwordx4 v8, s[8:11], s24 offen offset:0 lds
    buffer_load_dwordx4 v8, s[8:11], s24 offen offset:1024 lds
    buffer_load_dwordx4 v8, s[8:11], s24 offen offset:2048 lds
    buffer_load_dwordx4 v8, s[8:11], s24 offen offset:3072 lds
    s_add_u32 s24, s24, 16384
    s_add_u32 s30, s28, s44
    s_add_u32 s30, s30, 32768
    s_mov_b32 m0, s30
    s_nop 0
    buffer_load_dwordx4 v8, s[8:11], s25 offen offset:0 lds
    buffer_load_dwordx4 v8, s[8:11], s25 offen offset:1024 lds
    buffer_load_dwordx4 v8, s[8:11], s25 offen offset:2048 lds
    buffer_load_dwordx4 v8, s[8:11], s25 offen offset:3072 lds
    s_add_u32 s25, s25, 16384
    s_add_u32 s30, s28, s45
    s_mov_b32 m0, s30
    s_nop 0
    buffer_load_dwordx4 v8, s[8:11], s24 offen offset:0 lds
    buffer_load_dwordx4 v8, s[8:11], s24 offen offset:1024 lds
    buffer_load_dwordx4 v8, s[8:11], s24 offen offset:2048 lds
    buffer_load_dwordx4 v8, s[8:11], s24 offen offset:3072 lds
    s_add_u32 s24, s24, 16384
    s_waitcnt vmcnt(0)
    s_barrier
    ds_read_b128 v[160:163], v8 offset:0
    s_waitcnt lgkmcnt(0)
    v_mfma_f32_32x32x16_bf16 v[48:63], v[160:163], v[16:19], 0
    ds_read_b128 v[164:167], v8 offset:1024
    s_waitcnt lgkmcnt(0)
    v_mfma_f32_32x32x16_bf16 v[48:63], v[164:167], v[20:23], v[48:63]
    ds_read_b128 v[168:171], v8 offset:2048
    s_waitcnt lgkmcnt(0)
    v_mfma_f32_32x32x16_bf16 v[48:63], v[168:171], v[24:27], v[48:63]
    ds_read_b128 v[172:175], v8 offset:3072
    s_waitcnt lgkmcnt(0)
    v_mfma_f32_32x32x16_bf16 v[48:63], v[172:175], v[28:31], v[48:63]
    ds_read_b128 v[176:179], v8 offset:4096
    s_waitcnt lgkmcnt(0)
    v_mfma_f32_32x32x16_bf16 v[48:63], v[176:179], v[32:35], v[48:63]
    ds_read_b128 v[180:183], v8 offset:5120
    s_waitcnt lgkmcnt(0)
    v_mfma_f32_32x32x16_bf16 v[48:63], v[180:183], v[36:39], v[48:63]
    ds_read_b128 v[184:187], v8 offset:6144
    s_waitcnt lgkmcnt(0)
    v_mfma_f32_32x32x16_bf16 v[48:63], v[184:187], v[40:43], v[48:63]
    ds_read_b128 v[188:191], v8 offset:7168
    s_waitcnt lgkmcnt(0)
    v_mfma_f32_32x32x16_bf16 v[48:63], v[188:191], v[44:47], v[48:63]
    ds_read_b128 v[160:163], v8 offset:8192
    s_waitcnt lgkmcnt(0)
    v_mfma_f32_32x32x16_bf16 v[64:79], v[160:163], v[16:19], 0
    ds_read_b128 v[164:167], v8 offset:9216
    s_waitcnt lgkmcnt(0)
    v_mfma_f32_32x32x16_bf16 v[64:79], v[164:167], v[20:23], v[64:79]
    ds_read_b128 v[168:171], v8 offset:10240
    s_waitcnt lgkmcnt(0)
    v_mfma_f32_32x32x16_bf16 v[64:79], v[168:171], v[24:27], v[64:79]
    ds_read_b128 v[172:175], v8 offset:11264
    s_waitcnt lgkmcnt(0)
    v_mfma_f32_32x32x16_bf16 v[64:79], v[172:175], v[28:31], v[64:79]
    ds_read_b128 v[176:179], v8 offset:12288
    s_waitcnt lgkmcnt(0)
    v_mfma_f32_32x32x16_bf16 v[64:79], v[176:179], v[32:35], v[64:79]
    ds_read_b128 v[180:183], v8 offset:13312
    s_waitcnt lgkmcnt(0)
    v_mfma_f32_32x32x16_bf16 v[64:79], v[180:183], v[36:39], v[64:79]
    ds_read_b128 v[184:187], v8 offset:14336
    s_waitcnt lgkmcnt(0)
    v_mfma_f32_32x32x16_bf16 v[64:79], v[184:187], v[40:43], v[64:79]
    ds_read_b128 v[188:191], v8 offset:15360
    s_waitcnt lgkmcnt(0)
    v_mfma_f32_32x32x16_bf16 v[64:79], v[188:191], v[44:47], v[64:79]
    s_mov_b32 s31, 0
    s_sub_u32 s34, s21, 2
    s_cmp_lt_u32 s31, s34
    s_cbranch_scc1 attnb_m0
    s_nop 15
    s_lshl_b32 s34, s31, 6
    v_subrev_u32 v4, s34, v7
    v_mov_b32 v5, 0xf149f2ca
    v_cmp_gt_i32 vcc, 0, v4
    s_nop 1
    v_cndmask_b32 v48, v48, v5, vcc
    v_cmp_gt_i32 vcc, 1, v4
    s_nop 1
    v_cndmask_b32 v49, v49, v5, vcc
    v_cmp_gt_i32 vcc, 2, v4
    s_nop 1
    v_cndmask_b32 v50, v50, v5, vcc
    v_cmp_gt_i32 vcc, 3, v4
    s_nop 1
    v_cndmask_b32 v51, v51, v5, vcc
    v_cmp_gt_i32 vcc, 8, v4
    s_nop 1
    v_cndmask_b32 v52, v52, v5, vcc
    v_cmp_gt_i32 vcc, 9, v4
    s_nop 1
    v_cndmask_b32 v53, v53, v5, vcc
    v_cmp_gt_i32 vcc, 10, v4
    s_nop 1
    v_cndmask_b32 v54, v54, v5, vcc
    v_cmp_gt_i32 vcc, 11, v4
    s_nop 1
    v_cndmask_b32 v55, v55, v5, vcc
    v_cmp_gt_i32 vcc, 16, v4
    s_nop 1
    v_cndmask_b32 v56, v56, v5, vcc
    v_cmp_gt_i32 vcc, 17, v4
    s_nop 1
    v_cndmask_b32 v57, v57, v5, vcc
    v_cmp_gt_i32 vcc, 18, v4
    s_nop 1
    v_cndmask_b32 v58, v58, v5, vcc
    v_cmp_gt_i32 vcc, 19, v4
    s_nop 1
    v_cndmask_b32 v59, v59, v5, vcc
    v_cmp_gt_i32 vcc, 24, v4
    s_nop 1
    v_cndmask_b32 v60, v60, v5, vcc
    v_cmp_gt_i32 vcc, 25, v4
    s_nop 1
    v_cndmask_b32 v61, v61, v5, vcc
    v_cmp_gt_i32 vcc, 26, v4
    s_nop 1
    v_cndmask_b32 v62, v62, v5, vcc
    v_cmp_gt_i32 vcc, 27, v4
    s_nop 1
    v_cndmask_b32 v63, v63, v5, vcc
    v_cmp_gt_i32 vcc, 32, v4
    s_nop 1
    v_cndmask_b32 v64, v64, v5, vcc
    v_cmp_gt_i32 vcc, 33, v4
    s_nop 1
    v_cndmask_b32 v65, v65, v5, vcc
    v_cmp_gt_i32 vcc, 34, v4
    s_nop 1
    v_cndmask_b32 v66, v66, v5, vcc
    v_cmp_gt_i32 vcc, 35, v4
    s_nop 1
    v_cndmask_b32 v67, v67, v5, vcc
    v_cmp_gt_i32 vcc, 40, v4
    s_nop 1
    v_cndmask_b32 v68, v68, v5, vcc
    v_cmp_gt_i32 vcc, 41, v4
    s_nop 1
    v_cndmask_b32 v69, v69, v5, vcc
    v_cmp_gt_i32 vcc, 42, v4
    s_nop 1
    v_cndmask_b32 v70, v70, v5, vcc
    v_cmp_gt_i32 vcc, 43, v4
    s_nop 1
    v_cndmask_b32 v71, v71, v5, vcc
    v_cmp_gt_i32 vcc, 48, v4
    s_nop 1
    v_cndmask_b32 v72, v72, v5, vcc
    v_cmp_gt_i32 vcc, 49, v4
    s_nop 1
    v_cndmask_b32 v73, v73, v5, vcc
    v_cmp_gt_i32 vcc, 50, v4
    s_nop 1
    v_cndmask_b32 v74, v74, v5, vcc
    v_cmp_gt_i32 vcc, 51, v4
    s_nop 1
    v_cndmask_b32 v75, v75, v5, vcc
    v_cmp_gt_i32 vcc, 56, v4
    s_nop 1
    v_cndmask_b32 v76, v76, v5, vcc
    v_cmp_gt_i32 vcc, 57, v4
    s_nop 1
    v_cndmask_b32 v77, v77, v5, vcc
    v_cmp_gt_i32 vcc, 58, v4
    s_nop 1
    v_cndmask_b32 v78, v78, v5, vcc
    v_cmp_gt_i32 vcc, 59, v4
    s_nop 1
    v_cndmask_b32 v79, v79, v5, vcc
attnb_m0:
attnb_loop:
    s_add_u32 s32, s31, 1
    s_add_u32 s33, s31, 2
    s_cmp_ge_u32 s33, s21
    s_cbranch_scc1 attnb_nk0
    s_add_u32 s30, s28, s44
    s_mov_b32 m0, s30
    s_nop 0
    buffer_load_dwordx4 v8, s[8:11], s24 offen offset:0 lds
    buffer_load_dwordx4 v8, s[8:11], s24 offen offset:1024 lds
    buffer_load_dwordx4 v8, s[8:11], s24 offen offset:2048 lds
    buffer_load_dwordx4 v8, s[8:11], s24 offen offset:3072 lds
    s_add_u32 s24, s24, 16384
attnb_nk0:
    s_cmp_ge_u32 s32, s21
    s_cbranch_scc1 attnb_nv0
    s_add_u32 s30, s28, s45
    s_add_u32 s30, s30, 32768
    s_mov_b32 m0, s30
    s_nop 0
    buffer_load_dwordx4 v8, s[8:11], s25 offen offset:0 lds
    buffer_load_dwordx4 v8, s[8:11], s25 offen offset:1024 lds
    buffer_load_dwordx4 v8, s[8:11], s25 offen offset:2048 lds
    buffer_load_dwordx4 v8, s[8:11], s25 offen offset:3072 lds
    s_add_u32 s25, s25, 16384
attnb_nv0:
    v_add_u32 v6, 16384, v8
    v_add_u32 v9, 32768, v8
    s_nop 7
    v_max3_f32 v4, v48, v49, v50
    v_max3_f32 v4, v4, v51, v52
    v_max3_f32 v4, v4, v53, v54
    v_max3_f32 v4, v4, v55, v56
    v_max3_f32 v4, v4, v57, v58
    v_max3_f32 v4, v4, v59, v60
    v_max3_f32 v4, v4, v61, v62
    v_max3_f32 v4, v4, v63, v64
    v_max3_f32 v4, v4, v65, v66
    v_max3_f32 v4, v4, v67, v68
    v_max3_f32 v4, v4, v69, v70
    v_max3_f32 v4, v4, v71, v72
    v_max3_f32 v4, v4, v73, v74
    v_max3_f32 v4, v4, v75, v76
    v_max3_f32 v4, v4, v77, v78
    v_max_f32 v4, v4, v79
    v_mov_b32 v5, v4
    s_nop 1
    v_permlane32_swap_b32 v4, v5
    v_max3_f32 v4, v4, v5, v2
    v_cmp_gt_f32 vcc, v4, v2
    s_nop 4
    s_cbranch_vccz attnb_nors0
    v_sub_f32 v5, v2, v4
    v_mul_f32 v5, s40, v5
    v_exp_f32 v5, v5
    v_mov_b32 v2, v4
    v_mul_f32 v3, v3, v5
    v_mul_f32 v96, v96, v5
    v_mul_f32 v97, v97, v5
    v_mul_f32 v98, v98, v5
    v_mul_f32 v99, v99, v5
    v_mul_f32 v100, v100, v5
    v_mul_f32 v101, v101, v5
    v_mul_f32 v102, v102, v5
    v_mul_f32 v103, v103, v5
    v_mul_f32 v104, v104, v5
    v_mul_f32 v105, v105, v5
    v_mul_f32 v106, v106, v5
    v_mul_f32 v107, v107, v5
    v_mul_f32 v108, v108, v5
    v_mul_f32 v109, v109, v5
    v_mul_f32 v110, v110, v5
    v_mul_f32 v111, v111, v5
    v_mul_f32 v112, v112, v5
    v_mul_f32 v113, v113, v5
    v_mul_f32 v114, v114, v5
    v_mul_f32 v115, v115, v5
    v_mul_f32 v116, v116, v5
    v_mul_f32 v117, v117, v5
    v_mul_f32 v118, v118, v5
    v_mul_f32 v119, v119, v5
    v_mul_f32 v120, v120, v5
    v_mul_f32 v121, v121, v5
    v_mul_f32 v122, v122, v5
    v_mul_f32 v123, v123, v5
    v_mul_f32 v124, v124, v5
    v_mul_f32 v125, v125, v5
    v_mul_f32 v126, v126, v5
    v_mul_f32 v127, v127, v5
    v_mul_f32 v128, v128, v5
    v_mul_f32 v129, v129, v5
    v_mul_f32 v130, v130, v5
    v_mul_f32 v131, v131, v5
    v_mul_f32 v132, v132, v5
    v_mul_f32 v133, v133, v5
    v_mul_f32 v134, v134, v5
    v_mul_f32 v135, v135, v5
    v_mul_f32 v136, v136, v5
    v_mul_f32 v137, v137, v5
    v_mul_f32 v138, v138, v5
    v_mul_f32 v139, v139, v5
    v_mul_f32 v140, v140, v5
    v_mul_f32 v141, v141, v5
    v_mul_f32 v142, v142, v5
    v_mul_f32 v143, v143, v5
    v_mul_f32 v144, v144, v5
    v_mul_f32 v145, v145, v5
    v_mul_f32 v146, v146, v5
    v_mul_f32 v147, v147, v5
    v_mul_f32 v148, v148, v5
    v_mul_f32 v149, v149, v5
    v_mul_f32 v150, v150, v5
    v_mul_f32 v151, v151, v5
    v_mul_f32 v152, v152, v5
    v_mul_f32 v153, v153, v5
    v_mul_f32 v154, v154, v5
    v_mul_f32 v155, v155, v5
    v_mul_f32 v156, v156, v5
    v_mul_f32 v157, v157, v5
    v_mul_f32 v158, v158, v5
    v_mul_f32 v159, v159, v5
attnb_nors0:
    v_mul_f32 v4, s40, v2
    s_cmp_ge_u32 s32, s21
    s_cbranch_scc1 attnb_last0
    ds_read_b128 v[160:163], v6 offset:0
    ds_read_b128 v[164:167], v6 offset:1024
    ds_read_b128 v[168:171], v6 offset:2048
    ds_read_b128 v[172:175], v6 offset:3072
    ds_read_b128 v[176:179], v6 offset:4096
    s_waitcnt lgkmcnt(4)
    v_mfma_f32_32x32x16_bf16 v[192:207], v[160:163], v[16:19], 0
    v_fma_f32 v48, v48, s40, -v4
    v_fma_f32 v49, v49, s40, -v4
    v_fma_f32 v50, v50, s40, -v4
    v_fma_f32 v51, v51, s40, -v4
    v_fma_f32 v52, v52, s40, -v4
    v_fma_f32 v53, v53, s40, -v4
    v_fma_f32 v54, v54, s40, -v4
    v_fma_f32 v55, v55, s40, -v4
    ds_read_b128 v[180:183], v6 offset:5120
    s_waitcnt lgkmcnt(4)
    v_mfma_f32_32x32x16_bf16 v[192:207], v[164:167], v[20:23], v[192:207]
    v_exp_f32 v48, v48
    v_exp_f32 v49, v49
    v_exp_f32 v50, v50
    v_exp_f32 v51, v51
    v_exp_f32 v52, v52
    v_exp_f32 v53, v53
    v_exp_f32 v54, v54
    v_exp_f32 v55, v55
    ds_read_b128 v[184:187], v6 offset:6144
    s_waitcnt lgkmcnt(4)
    v_mfma_f32_32x32x16_bf16 v[192:207], v[168:171], v[24:27], v[192:207]
    v_fma_f32 v56, v56, s40, -v4
    v_fma_f32 v57, v57, s40, -v4
    v_fma_f32 v58, v58, s40, -v4
    v_fma_f32 v59, v59, s40, -v4
    v_fma_f32 v60, v60, s40, -v4
    v_fma_f32 v61, v61, s40, -v4
    v_fma_f32 v62, v62, s40, -v4
    v_fma_f32 v63, v63, s40, -v4
    ds_read_b128 v[188:191], v6 offset:7168
    s_waitcnt lgkmcnt(4)
    v_mfma_f32_32x32x16_bf16 v[192:207], v[172:175], v[28:31], v[192:207]
    v_add_f32 v3, v3, v48
    v_add_f32 v3, v3, v49
    v_add_f32 v3, v3, v50
    v_add_f32 v3, v3, v51
    v_add_f32 v3, v3, v52
    v_add_f32 v3, v3, v53
    v_add_f32 v3, v3, v54
    v_add_f32 v3, v3, v55
    ds_read_b128 v[160:163], v6 offset:8192
    s_waitcnt lgkmcnt(4)
    v_mfma_f32_32x32x16_bf16 v[192:207], v[176:179], v[32:35], v[192:207]
    v_cvt_pk_bf16_f32 v80, v48, v49
    v_cvt_pk_bf16_f32 v81, v50, v51
    v_cvt_pk_bf16_f32 v82, v52, v53
    v_cvt_pk_bf16_f32 v83, v54, v55
    v_exp_f32 v56, v56
    v_exp_f32 v57, v57
    v_exp_f32 v58, v58
    v_exp_f32 v59, v59
    ds_read_b128 v[164:167], v6 offset:9216
    s_waitcnt lgkmcnt(4)
    v_mfma_f32_32x32x16_bf16 v[192:207], v[180:183], v[36:39], v[192:207]
    v_exp_f32 v60, v60
    v_exp_f32 v61, v61
    v_exp_f32 v62, v62
    v_exp_f32 v63, v63
    v_fma_f32 v64, v64, s40, -v4
    v_fma_f32 v65, v65, s40, -v4
    v_fma_f32 v66, v66, s40, -v4
    v_fma_f32 v67, v67, s40, -v4
    ds_read_b128 v[168:171], v6 offset:10240
    s_waitcnt lgkmcnt(4)
    v_mfma_f32_32x32x16_bf16 v[192:207], v[184:187], v[40:43], v[192:207]
    v_fma_f32 v68, v68, s40, -v4
    v_fma_f32 v69, v69, s40, -v4
    v_fma_f32 v70, v70, s40, -v4
    v_fma_f32 v71, v71, s40, -v4
    v_add_f32 v3, v3, v56
    v_add_f32 v3, v3, v57
    v_add_f32 v3, v3, v58
    v_add_f32 v3, v3, v59
    ds_read_b128 v[172:175], v6 offset:11264
    s_waitcnt lgkmcnt(4)
    v_mfma_f32_32x32x16_bf16 v[192:207], v[188:191], v[44:47], v[192:207]
    v_add_f32 v3, v3, v60
    v_add_f32 v3, v3, v61
    v_add_f32 v3, v3, v62
    v_add_f32 v3, v3, v63
    v_cvt_pk_bf16_f32 v84, v56, v57
    v_cvt_pk_bf16_f32 v85, v58, v59
    v_cvt_pk_bf16_f32 v86, v60, v61
    v_cvt_pk_bf16_f32 v87, v62, v63
    ds_read_b128 v[176:179], v6 offset:12288
    s_waitcnt lgkmcnt(4)
    v_mfma_f32_32x32x16_bf16 v[208:223], v[160:163], v[16:19], 0
    v_exp_f32 v64, v64
    v_exp_f32 v65, v65
    v_exp_f32 v66, v66
    v_exp_f32 v67, v67
    v_exp_f32 v68, v68
    v_exp_f32 v69, v69
    v_exp_f32 v70, v70
    v_exp_f32 v71, v71
    ds_read_b128 v[180:183], v6 offset:13312
    s_waitcnt lgkmcnt(4)
    v_mfma_f32_32x32x16_bf16 v[208:223], v[164:167], v[20:23], v[208:223]
    v_fma_f32 v72, v72, s40, -v4
    v_fma_f32 v73, v73, s40, -v4
    v_fma_f32 v74, v74, s40, -v4
    v_fma_f32 v75, v75, s40, -v4
    v_fma_f32 v76, v76, s40, -v4
    v_fma_f32 v77, v77, s40, -v4
    v_fma_f32 v78, v78, s40, -v4
    v_fma_f32 v79, v79, s40, -v4
    ds_read_b128 v[184:187], v6 offset:14336
    s_waitcnt lgkmcnt(4)
    v_mfma_f32_32x32x16_bf16 v[208:223], v[168:171], v[24:27], v[208:223]
    v_add_f32 v3, v3, v64
    v_add_f32 v3, v3, v65
    v_add_f32 v3, v3, v66
    v_add_f32 v3, v3, v67
    v_add_f32 v3, v3, v68
    v_add_f32 v3, v3, v69
    v_add_f32 v3, v3, v70
    v_add_f32 v3, v3, v71
    ds_read_b128 v[188:191], v6 offset:15360
    s_waitcnt lgkmcnt(4)
    v_mfma_f32_32x32x16_bf16 v[208:223], v[172:175], v[28:31], v[208:223]
    v_cvt_pk_bf16_f32 v88, v64, v65
    v_cvt_pk_bf16_f32 v89, v66, v67
    v_cvt_pk_bf16_f32 v90, v68, v69
    v_cvt_pk_bf16_f32 v91, v70, v71
    v_exp_f32 v72, v72
    v_exp_f32 v73, v73
    v_exp_f32 v74, v74
    v_exp_f32 v75, v75
    s_waitcnt lgkmcnt(3)
    v_mfma_f32_32x32x16_bf16 v[208:223], v[176:179], v[32:35], v[208:223]
    v_exp_f32 v76, v76
    v_exp_f32 v77, v77
    v_exp_f32 v78, v78
    v_exp_f32 v79, v79
    s_nop 0
    v_add_f32 v3, v3, v72
    v_add_f32 v3, v3, v73
    v_add_f32 v3, v3, v74
    s_waitcnt lgkmcnt(2)
    v_mfma_f32_32x32x16_bf16 v[208:223], v[180:183], v[36:39], v[208:223]
    v_add_f32 v3, v3, v75
    v_add_f32 v3, v3, v76
    v_add_f32 v3, v3, v77
    v_add_f32 v3, v3, v78
    v_add_f32 v3, v3, v79
    v_cvt_pk_bf16_f32 v92, v72, v73
    v_cvt_pk_bf16_f32 v93, v74, v75
    v_cvt_pk_bf16_f32 v94, v76, v77
    s_waitcnt lgkmcnt(1)
    v_mfma_f32_32x32x16_bf16 v[208:223], v[184:187], v[40:43], v[208:223]
    v_cvt_pk_bf16_f32 v95, v78, v79
    s_waitcnt lgkmcnt(0)
    v_mfma_f32_32x32x16_bf16 v[208:223], v[188:191], v[44:47], v[208:223]
    s_branch attnb_pv0
attnb_last0:
    v_fma_f32 v48, v48, s40, -v4
    v_fma_f32 v49, v49, s40, -v4
    v_fma_f32 v50, v50, s40, -v4
    v_fma_f32 v51, v51, s40, -v4
    v_fma_f32 v52, v52, s40, -v4
    v_fma_f32 v53, v53, s40, -v4
    v_fma_f32 v54, v54, s40, -v4
    v_fma_f32 v55, v55, s40, -v4
    v_exp_f32 v48, v48
    v_exp_f32 v49, v49
    v_exp_f32 v50, v50
    v_exp_f32 v51, v51
    v_exp_f32 v52, v52
    v_exp_f32 v53, v53
    v_exp_f32 v54, v54
    v_exp_f32 v55, v55
    v_fma_f32 v56, v56, s40, -v4
    v_fma_f32 v57, v57, s40, -v4
    v_fma_f32 v58, v58, s40, -v4
    v_fma_f32 v59, v59, s40, -v4
    v_fma_f32 v60, v60, s40, -v4
    v_fma_f32 v61, v61, s40, -v4
    v_fma_f32 v62, v62, s40, -v4
    v_fma_f32 v63, v63, s40, -v4
    v_add_f32 v3, v3, v48
    v_add_f32 v3, v3, v49
    v_add_f32 v3, v3, v50
    v_add_f32 v3, v3, v51
    v_add_f32 v3, v3, v52
    v_add_f32 v3, v3, v53
    v_add_f32 v3, v3, v54
    v_add_f32 v3, v3, v55
    v_cvt_pk_bf16_f32 v80, v48, v49
    v_cvt_pk_bf16_f32 v81, v50, v51
    v_cvt_pk_bf16_f32 v82, v52, v53
    v_cvt_pk_bf16_f32 v83, v54, v55
    v_exp_f32 v56, v56
    v_exp_f32 v57, v57
    v_exp_f32 v58, v58
    v_exp_f32 v59, v59
    v_exp_f32 v60, v60
    v_exp_f32 v61, v61
    v_exp_f32 v62, v62
    v_exp_f32 v63, v63
    v_fma_f32 v64, v64, s40, -v4
    v_fma_f32 v65, v65, s40, -v4
    v_fma_f32 v66, v66, s40, -v4
    v_fma_f32 v67, v67, s40, -v4
    v_fma_f32 v68, v68, s40, -v4
    v_fma_f32 v69, v69, s40, -v4
    v_fma_f32 v70, v70, s40, -v4
    v_fma_f32 v71, v71, s40, -v4
    v_add_f32 v3, v3, v56
    v_add_f32 v3, v3, v57
    v_add_f32 v3, v3, v58
    v_add_f32 v3, v3, v59
    v_add_f32 v3, v3, v60
    v_add_f32 v3, v3, v61
    v_add_f32 v3, v3, v62
    v_add_f32 v3, v3, v63
    v_cvt_pk_bf16_f32 v84, v56, v57
    v_cvt_pk_bf16_f32 v85, v58, v59
    v_cvt_pk_bf16_f32 v86, v60, v61
    v_cvt_pk_bf16_f32 v87, v62, v63
    v_exp_f32 v64, v64
    v_exp_f32 v65, v65
    v_exp_f32 v66, v66
    v_exp_f32 v67, v67
    v_exp_f32 v68, v68
    v_exp_f32 v69, v69
    v_exp_f32 v70, v70
    v_exp_f32 v71, v71
    v_fma_f32 v72, v72, s40, -v4
    v_fma_f32 v73, v73, s40, -v4
    v_fma_f32 v74, v74, s40, -v4
    v_fma_f32 v75, v75, s40, -v4
    v_fma_f32 v76, v76, s40, -v4
    v_fma_f32 v77, v77, s40, -v4
    v_fma_f32 v78, v78, s40, -v4
    v_fma_f32 v79, v79, s40, -v4
    v_add_f32 v3, v3, v64
    v_add_f32 v3, v3, v65
    v_add_f32 v3, v3, v66
    v_add_f32 v3, v3, v67
    v_add_f32 v3, v3, v68
    v_add_f32 v3, v3, v69
    v_add_f32 v3, v3, v70
    v_add_f32 v3, v3, v71
    v_cvt_pk_bf16_f32 v88, v64, v65
    v_cvt_pk_bf16_f32 v89, v66, v67
    v_cvt_pk_bf16_f32 v90, v68, v69
    v_cvt_pk_bf16_f32 v91, v70, v71
    v_exp_f32 v72, v72
    v_exp_f32 v73, v73
    v_exp_f32 v74, v74
    v_exp_f32 v75, v75
    v_exp_f32 v76, v76
    v_exp_f32 v77, v77
    v_exp_f32 v78, v78
    v_exp_f32 v79, v79
    s_nop 0
    v_add_f32 v3, v3, v72
    v_add_f32 v3, v3, v73
    v_add_f32 v3, v3, v74
    v_add_f32 v3, v3, v75
    v_add_f32 v3, v3, v76
    v_add_f32 v3, v3, v77
    v_add_f32 v3, v3, v78
    v_add_f32 v3, v3, v79
    v_cvt_pk_bf16_f32 v92, v72, v73
    v_cvt_pk_bf16_f32 v93, v74, v75
    v_cvt_pk_bf16_f32 v94, v76, v77
    v_cvt_pk_bf16_f32 v95, v78, v79
attnb_pv0:
    ds_read_b128 v[160:163], v9 offset:0
    ds_read_b128 v[164:167], v9 offset:1024
    ds_read_b128 v[168:171], v9 offset:2048
    ds_read_b128 v[172:175], v9 offset:3072
    ds_read_b128 v[176:179], v9 offset:4096
    ds_read_b128 v[180:183], v9 offset:5120
    ds_read_b128 v[184:187], v9 offset:6144
    s_waitcnt lgkmcnt(6)
    v_mfma_f32_32x32x16_bf16 v[96:111], v[160:163], v[80:83], v[96:111]
    ds_read_b128 v[188:191], v9 offset:7168
    s_waitcnt lgkmcnt(6)
    v_mfma_f32_32x32x16_bf16 v[112:127], v[164:167], v[80:83], v[112:127]
    ds_read_b128 v[160:163], v9 offset:8192
    s_waitcnt lgkmcnt(6)
    v_mfma_f32_32x32x16_bf16 v[128:143], v[168:171], v[80:83], v[128:143]
    ds_read_b128 v[164:167], v9 offset:9216
    s_waitcnt lgkmcnt(6)
    v_mfma_f32_32x32x16_bf16 v[144:159], v[172:175], v[80:83], v[144:159]
    ds_read_b128 v[168:171], v9 offset:10240
    s_waitcnt lgkmcnt(6)
    v_mfma_f32_32x32x16_bf16 v[96:111], v[176:179], v[84:87], v[96:111]
    ds_read_b128 v[172:175], v9 offset:11264
    s_waitcnt lgkmcnt(6)
    v_mfma_f32_32x32x16_bf16 v[112:127], v[180:183], v[84:87], v[112:127]
    ds_read_b128 v[176:179], v9 offset:12288
    s_waitcnt lgkmcnt(6)
    v_mfma_f32_32x32x16_bf16 v[128:143], v[184:187], v[84:87], v[128:143]
    ds_read_b128 v[180:183], v9 offset:13312
    s_waitcnt lgkmcnt(6)
    v_mfma_f32_32x32x16_bf16 v[144:159], v[188:191], v[84:87], v[144:159]
    ds_read_b128 v[184:187], v9 offset:14336
    s_waitcnt lgkmcnt(6)
    v_mfma_f32_32x32x16_bf16 v[96:111], v[160:163], v[88:91], v[96:111]
    ds_read_b128 v[188:191], v9 offset:15360
    s_waitcnt lgkmcnt(6)
    v_mfma_f32_32x32x16_bf16 v[112:127], v[164:167], v[88:91], v[112:127]
    s_waitcnt lgkmcnt(5)
    v_mfma_f32_32x32x16_bf16 v[128:143], v[168:171], v[88:91], v[128:143]
    s_waitcnt lgkmcnt(4)
    v_mfma_f32_32x32x16_bf16 v[144:159], v[172:175], v[88:91], v[144:159]
    s_waitcnt lgkmcnt(3)
    v_mfma_f32_32x32x16_bf16 v[96:111], v[176:179], v[92:95], v[96:111]
    s_waitcnt lgkmcnt(2)
    v_mfma_f32_32x32x16_bf16 v[112:127], v[180:183], v[92:95], v[112:127]
    s_waitcnt lgkmcnt(1)
    v_mfma_f32_32x32x16_bf16 v[128:143], v[184:187], v[92:95], v[128:143]
    s_waitcnt lgkmcnt(0)
    v_mfma_f32_32x32x16_bf16 v[144:159], v[188:191], v[92:95], v[144:159]
    s_sub_u32 s34, s21, 2
    s_cmp_lt_u32 s32, s34
    s_cbranch_scc1 attnb_m10
    s_nop 15
    s_lshl_b32 s34, s32, 6
    v_subrev_u32 v4, s34, v7
    v_mov_b32 v5, 0xf149f2ca
    v_cmp_gt_i32 vcc, 0, v4
    s_nop 1
    v_cndmask_b32 v192, v192, v5, vcc
    v_cmp_gt_i32 vcc, 1, v4
    s_nop 1
    v_cndmask_b32 v193, v193, v5, vcc
    v_cmp_gt_i32 vcc, 2, v4
    s_nop 1
    v_cndmask_b32 v194, v194, v5, vcc
    v_cmp_gt_i32 vcc, 3, v4
    s_nop 1
    v_cndmask_b32 v195, v195, v5, vcc
    v_cmp_gt_i32 vcc, 8, v4
    s_nop 1
    v_cndmask_b32 v196, v196, v5, vcc
    v_cmp_gt_i32 vcc, 9, v4
    s_nop 1
    v_cndmask_b32 v197, v197, v5, vcc
    v_cmp_gt_i32 vcc, 10, v4
    s_nop 1
    v_cndmask_b32 v198, v198, v5, vcc
    v_cmp_gt_i32 vcc, 11, v4
    s_nop 1
    v_cndmask_b32 v199, v199, v5, vcc
    v_cmp_gt_i32 vcc, 16, v4
    s_nop 1
    v_cndmask_b32 v200, v200, v5, vcc
    v_cmp_gt_i32 vcc, 17, v4
    s_nop 1
    v_cndmask_b32 v201, v201, v5, vcc
    v_cmp_gt_i32 vcc, 18, v4
    s_nop 1
    v_cndmask_b32 v202, v202, v5, vcc
    v_cmp_gt_i32 vcc, 19, v4
    s_nop 1
    v_cndmask_b32 v203, v203, v5, vcc
    v_cmp_gt_i32 vcc, 24, v4
    s_nop 1
    v_cndmask_b32 v204, v204, v5, vcc
    v_cmp_gt_i32 vcc, 25, v4
    s_nop 1
    v_cndmask_b32 v205, v205, v5, vcc
    v_cmp_gt_i32 vcc, 26, v4
    s_nop 1
    v_cndmask_b32 v206, v206, v5, vcc
    v_cmp_gt_i32 vcc, 27, v4
    s_nop 1
    v_cndmask_b32 v207, v207, v5, vcc
    v_cmp_gt_i32 vcc, 32, v4
    s_nop 1
    v_cndmask_b32 v208, v208, v5, vcc
    v_cmp_gt_i32 vcc, 33, v4
    s_nop 1
    v_cndmask_b32 v209, v209, v5, vcc
    v_cmp_gt_i32 vcc, 34, v4
    s_nop 1
    v_cndmask_b32 v210, v210, v5, vcc
    v_cmp_gt_i32 vcc, 35, v4
    s_nop 1
    v_cndmask_b32 v211, v211, v5, vcc
    v_cmp_gt_i32 vcc, 40, v4
    s_nop 1
    v_cndmask_b32 v212, v212, v5, vcc
    v_cmp_gt_i32 vcc, 41, v4
    s_nop 1
    v_cndmask_b32 v213, v213, v5, vcc
    v_cmp_gt_i32 vcc, 42, v4
    s_nop 1
    v_cndmask_b32 v214, v214, v5, vcc
    v_cmp_gt_i32 vcc, 43, v4
    s_nop 1
    v_cndmask_b32 v215, v215, v5, vcc
    v_cmp_gt_i32 vcc, 48, v4
    s_nop 1
    v_cndmask_b32 v216, v216, v5, vcc
    v_cmp_gt_i32 vcc, 49, v4
    s_nop 1
    v_cndmask_b32 v217, v217, v5, vcc
    v_cmp_gt_i32 vcc, 50, v4
    s_nop 1
    v_cndmask_b32 v218, v218, v5, vcc
    v_cmp_gt_i32 vcc, 51, v4
    s_nop 1
    v_cndmask_b32 v219, v219, v5, vcc
    v_cmp_gt_i32 vcc, 56, v4
    s_nop 1
    v_cndmask_b32 v220, v220, v5, vcc
    v_cmp_gt_i32 vcc, 57, v4
    s_nop 1
    v_cndmask_b32 v221, v221, v5, vcc
    v_cmp_gt_i32 vcc, 58, v4
    s_nop 1
    v_cndmask_b32 v222, v222, v5, vcc
    v_cmp_gt_i32 vcc, 59, v4
    s_nop 1
    v_cndmask_b32 v223, v223, v5, vcc
attnb_m10:
    s_waitcnt vmcnt(0) lgkmcnt(0)
    s_barrier
    s_add_u32 s31, s31, 1
    s_cmp_ge_u32 s31, s21
    s_cbranch_scc1 attnb_done
    s_add_u32 s32, s31, 1
    s_add_u32 s33, s31, 2
    s_cmp_ge_u32 s33, s21
    s_cbranch_scc1 attnb_nk1
    s_add_u32 s30, s28, s45
    s_mov_b32 m0, s30
    s_nop 0
    buffer_load_dwordx4 v8, s[8:11], s24 offen offset:0 lds
    buffer_load_dwordx4 v8, s[8:11], s24 offen offset:1024 lds
    buffer_load_dwordx4 v8, s[8:11], s24 offen offset:2048 lds
    buffer_load_dwordx4 v8, s[8:11], s24 offen offset:3072 lds
    s_add_u32 s24, s24, 16384
attnb_nk1:
    s_cmp_ge_u32 s32, s21
    s_cbranch_scc1 attnb_nv1
    s_add_u32 s30, s28, s44
    s_add_u32 s30, s30, 32768
    s_mov_b32 m0, s30
    s_nop 0
    buffer_load_dwordx4 v8, s[8:11], s25 offen offset:0 lds
    buffer_load_dwordx4 v8, s[8:11], s25 offen offset:1024 lds
    buffer_load_dwordx4 v8, s[8:11], s25 offen offset:2048 lds
    buffer_load_dwordx4 v8, s[8:11], s25 offen offset:3072 lds
    s_add_u32 s25, s25, 16384
attnb_nv1:
    v_add_u32 v6, 0, v8
    v_add_u32 v9, 49152, v8
    s_nop 7
    v_max3_f32 v4, v192, v193, v194
    v_max3_f32 v4, v4, v195, v196
    v_max3_f32 v4, v4, v197, v198
    v_max3_f32 v4, v4, v199, v200
    v_max3_f32 v4, v4, v201, v202
    v_max3_f32 v4, v4, v203, v204
    v_max3_f32 v4, v4, v205, v206
    v_max3_f32 v4, v4, v207, v208
    v_max3_f32 v4, v4, v209, v210
    v_max3_f32 v4, v4, v211, v212
    v_max3_f32 v4, v4, v213, v214
    v_max3_f32 v4, v4, v215, v216
    v_max3_f32 v4, v4, v217, v218
    v_max3_f32 v4, v4, v219, v220
    v_max3_f32 v4, v4, v221, v222
    v_max_f32 v4, v4, v223
    v_mov_b32 v5, v4
    s_nop 1
    v_permlane32_swap_b32 v4, v5
    v_max3_f32 v4, v4, v5, v2
    v_cmp_gt_f32 vcc, v4, v2
    s_nop 4
    s_cbranch_vccz attnb_nors1
    v_sub_f32 v5, v2, v4
    v_mul_f32 v5, s40, v5
    v_exp_f32 v5, v5
    v_mov_b32 v2, v4
    v_mul_f32 v3, v3, v5
    v_mul_f32 v96, v96, v5
    v_mul_f32 v97, v97, v5
    v_mul_f32 v98, v98, v5
    v_mul_f32 v99, v99, v5
    v_mul_f32 v100, v100, v5
    v_mul_f32 v101, v101, v5
    v_mul_f32 v102, v102, v5
    v_mul_f32 v103, v103, v5
    v_mul_f32 v104, v104, v5
    v_mul_f32 v105, v105, v5
    v_mul_f32 v106, v106, v5
    v_mul_f32 v107, v107, v5
    v_mul_f32 v108, v108, v5
    v_mul_f32 v109, v109, v5
    v_mul_f32 v110, v110, v5
    v_mul_f32 v111, v111, v5
    v_mul_f32 v112, v112, v5
    v_mul_f32 v113, v113, v5
    v_mul_f32 v114, v114, v5
    v_mul_f32 v115, v115, v5
    v_mul_f32 v116, v116, v5
    v_mul_f32 v117, v117, v5
    v_mul_f32 v118, v118, v5
    v_mul_f32 v119, v119, v5
    v_mul_f32 v120, v120, v5
    v_mul_f32 v121, v121, v5
    v_mul_f32 v122, v122, v5
    v_mul_f32 v123, v123, v5
    v_mul_f32 v124, v124, v5
    v_mul_f32 v125, v125, v5
    v_mul_f32 v126, v126, v5
    v_mul_f32 v127, v127, v5
    v_mul_f32 v128, v128, v5
    v_mul_f32 v129, v129, v5
    v_mul_f32 v130, v130, v5
    v_mul_f32 v131, v131, v5
    v_mul_f32 v132, v132, v5
    v_mul_f32 v133, v133, v5
    v_mul_f32 v134, v134, v5
    v_mul_f32 v135, v135, v5
    v_mul_f32 v136, v136, v5
    v_mul_f32 v137, v137, v5
    v_mul_f32 v138, v138, v5
    v_mul_f32 v139, v139, v5
    v_mul_f32 v140, v140, v5
    v_mul_f32 v141, v141, v5
    v_mul_f32 v142, v142, v5
    v_mul_f32 v143, v143, v5
    v_mul_f32 v144, v144, v5
    v_mul_f32 v145, v145, v5
    v_mul_f32 v146, v146, v5
    v_mul_f32 v147, v147, v5
    v_mul_f32 v148, v148, v5
    v_mul_f32 v149, v149, v5
    v_mul_f32 v150, v150, v5
    v_mul_f32 v151, v151, v5
    v_mul_f32 v152, v152, v5
    v_mul_f32 v153, v153, v5
    v_mul_f32 v154, v154, v5
    v_mul_f32 v155, v155, v5
    v_mul_f32 v156, v156, v5
    v_mul_f32 v157, v157, v5
    v_mul_f32 v158, v158, v5
    v_mul_f32 v159, v159, v5
attnb_nors1:
    v_mul_f32 v4, s40, v2
    s_cmp_ge_u32 s32, s21
    s_cbranch_scc1 attnb_last1
    ds_read_b128 v[160:163], v6 offset:0
    ds_read_b128 v[164:167], v6 offset:1024
    ds_read_b128 v[168:171], v6 offset:2048
    ds_read_b128 v[172:175], v6 offset:3072
    ds_read_b128 v[176:179], v6 offset:4096
    s_waitcnt lgkmcnt(4)
    v_mfma_f32_32x32x16_bf16 v[48:63], v[160:163], v[16:19], 0
    v_fma_f32 v192, v192, s40, -v4
    v_fma_f32 v193, v193, s40, -v4
    v_fma_f32 v194, v194, s40, -v4
    v_fma_f32 v195, v195, s40, -v4
    v_fma_f32 v196, v196, s40, -v4
    v_fma_f32 v197, v197, s40, -v4
    v_fma_f32 v198, v198, s40, -v4
    v_fma_f32 v199, v199, s40, -v4
    ds_read_b128 v[180:183], v6 offset:5120
    s_waitcnt lgkmcnt(4)
    v_mfma_f32_32x32x16_bf16 v[48:63], v[164:167], v[20:23], v[48:63]
    v_exp_f32 v192, v192
    v_exp_f32 v193, v193
    v_exp_f32 v194, v194
    v_exp_f32 v195, v195
    v_exp_f32 v196, v196
    v_exp_f32 v197, v197
    v_exp_f32 v198, v198
    v_exp_f32 v199, v199
    ds_read_b128 v[184:187], v6 offset:6144
    s_waitcnt lgkmcnt(4)
    v_mfma_f32_32x32x16_bf16 v[48:63], v[168:171], v[24:27], v[48:63]
    v_fma_f32 v200, v200, s40, -v4
    v_fma_f32 v201, v201, s40, -v4
    v_fma_f32 v202, v202, s40, -v4
    v_fma_f32 v203, v203, s40, -v4
    v_fma_f32 v204, v204, s40, -v4
    v_fma_f32 v205, v205, s40, -v4
    v_fma_f32 v206, v206, s40, -v4
    v_fma_f32 v207, v207, s40, -v4
    ds_read_b128 v[188:191], v6 offset:7168
    s_waitcnt lgkmcnt(4)
    v_mfma_f32_32x32x16_bf16 v[48:63], v[172:175], v[28:31], v[48:63]
    v_add_f32 v3, v3, v192
    v_add_f32 v3, v3, v193
    v_add_f32 v3, v3, v194
    v_add_f32 v3, v3, v195
    v_add_f32 v3, v3, v196
    v_add_f32 v3, v3, v197
    v_add_f32 v3, v3, v198
    v_add_f32 v3, v3, v199
    ds_read_b128 v[160:163], v6 offset:8192
    s_waitcnt lgkmcnt(4)
    v_mfma_f32_32x32x16_bf16 v[48:63], v[176:179], v[32:35], v[48:63]
    v_cvt_pk_bf16_f32 v80, v192, v193
    v_cvt_pk_bf16_f32 v81, v194, v195
    v_cvt_pk_bf16_f32 v82, v196, v197
    v_cvt_pk_bf16_f32 v83, v198, v199
    v_exp_f32 v200, v200
    v_exp_f32 v201, v201
    v_exp_f32 v202, v202
    v_exp_f32 v203, v203
    ds_read_b128 v[164:167], v6 offset:9216
    s_waitcnt lgkmcnt(4)
    v_mfma_f32_32x32x16_bf16 v[48:63], v[180:183], v[36:39], v[48:63]
    v_exp_f32 v204, v204
    v_exp_f32 v205, v205
    v_exp_f32 v206, v206
    v_exp_f32 v207, v207
    v_fma_f32 v208, v208, s40, -v4
    v_fma_f32 v209, v209, s40, -v4
    v_fma_f32 v210, v210, s40, -v4
    v_fma_f32 v211, v211, s40, -v4
    ds_read_b128 v[168:171], v6 offset:10240
    s_waitcnt lgkmcnt(4)
    v_mfma_f32_32x32x16_bf16 v[48:63], v[184:187], v[40:43], v[48:63]
    v_fma_f32 v212, v212, s40, -v4
    v_fma_f32 v213, v213, s40, -v4
    v_fma_f32 v214, v214, s40, -v4
    v_fma_f32 v215, v215, s40, -v4
    v_add_f32 v3, v3, v200
    v_add_f32 v3, v3, v201
    v_add_f32 v3, v3, v202
    v_add_f32 v3, v3, v203
    ds_read_b128 v[172:175], v6 offset:11264
    s_waitcnt lgkmcnt(4)
    v_mfma_f32_32x32x16_bf16 v[48:63], v[188:191], v[44:47], v[48:63]
    v_add_f32 v3, v3, v204
    v_add_f32 v3, v3, v205
    v_add_f32 v3, v3, v206
    v_add_f32 v3, v3, v207
    v_cvt_pk_bf16_f32 v84, v200, v201
    v_cvt_pk_bf16_f32 v85, v202, v203
    v_cvt_pk_bf16_f32 v86, v204, v205
    v_cvt_pk_bf16_f32 v87, v206, v207
    ds_read_b128 v[176:179], v6 offset:12288
    s_waitcnt lgkmcnt(4)
    v_mfma_f32_32x32x16_bf16 v[64:79], v[160:163], v[16:19], 0
    v_exp_f32 v208, v208
    v_exp_f32 v209, v209
    v_exp_f32 v210, v210
    v_exp_f32 v211, v211
    v_exp_f32 v212, v212
    v_exp_f32 v213, v213
    v_exp_f32 v214, v214
    v_exp_f32 v215, v215
    ds_read_b128 v[180:183], v6 offset:13312
    s_waitcnt lgkmcnt(4)
    v_mfma_f32_32x32x16_bf16 v[64:79], v[164:167], v[20:23], v[64:79]
    v_fma_f32 v216, v216, s40, -v4
    v_fma_f32 v217, v217, s40, -v4
    v_fma_f32 v218, v218, s40, -v4
    v_fma_f32 v219, v219, s40, -v4
    v_fma_f32 v220, v220, s40, -v4
    v_fma_f32 v221, v221, s40, -v4
    v_fma_f32 v222, v222, s40, -v4
    v_fma_f32 v223, v223, s40, -v4
    ds_read_b128 v[184:187], v6 offset:14336
    s_waitcnt lgkmcnt(4)
    v_mfma_f32_32x32x16_bf16 v[64:79], v[168:171], v[24:27], v[64:79]
    v_add_f32 v3, v3, v208
    v_add_f32 v3, v3, v209
    v_add_f32 v3, v3, v210
    v_add_f32 v3, v3, v211
    v_add_f32 v3, v3, v212
    v_add_f32 v3, v3, v213
    v_add_f32 v3, v3, v214
    v_add_f32 v3, v3, v215
    ds_read_b128 v[188:191], v6 offset:15360
    s_waitcnt lgkmcnt(4)
    v_mfma_f32_32x32x16_bf16 v[64:79], v[172:175], v[28:31], v[64:79]
    v_cvt_pk_bf16_f32 v88, v208, v209
    v_cvt_pk_bf16_f32 v89, v210, v211
    v_cvt_pk_bf16_f32 v90, v212, v213
    v_cvt_pk_bf16_f32 v91, v214, v215
    v_exp_f32 v216, v216
    v_exp_f32 v217, v217
    v_exp_f32 v218, v218
    v_exp_f32 v219, v219
    s_waitcnt lgkmcnt(3)
    v_mfma_f32_32x32x16_bf16 v[64:79], v[176:179], v[32:35], v[64:79]
    v_exp_f32 v220, v220
    v_exp_f32 v221, v221
    v_exp_f32 v222, v222
    v_exp_f32 v223, v223
    s_nop 0
    v_add_f32 v3, v3, v216
    v_add_f32 v3, v3, v217
    v_add_f32 v3, v3, v218
    s_waitcnt lgkmcnt(2)
    v_mfma_f32_32x32x16_bf16 v[64:79], v[180:183], v[36:39], v[64:79]
    v_add_f32 v3, v3, v219
    v_add_f32 v3, v3, v220
    v_add_f32 v3, v3, v221
    v_add_f32 v3, v3, v222
    v_add_f32 v3, v3, v223
    v_cvt_pk_bf16_f32 v92, v216, v217
    v_cvt_pk_bf16_f32 v93, v218, v219
    v_cvt_pk_bf16_f32 v94, v220, v221
    s_waitcnt lgkmcnt(1)
    v_mfma_f32_32x32x16_bf16 v[64:79], v[184:187], v[40:43], v[64:79]
    v_cvt_pk_bf16_f32 v95, v222, v223
    s_waitcnt lgkmcnt(0)
    v_mfma_f32_32x32x16_bf16 v[64:79], v[188:191], v[44:47], v[64:79]
    s_branch attnb_pv1
attnb_last1:
    v_fma_f32 v192, v192, s40, -v4
    v_fma_f32 v193, v193, s40, -v4
    v_fma_f32 v194, v194, s40, -v4
    v_fma_f32 v195, v195, s40, -v4
    v_fma_f32 v196, v196, s40, -v4
    v_fma_f32 v197, v197, s40, -v4
    v_fma_f32 v198, v198, s40, -v4
    v_fma_f32 v199, v199, s40, -v4
    v_exp_f32 v192, v192
    v_exp_f32 v193, v193
    v_exp_f32 v194, v194
    v_exp_f32 v195, v195
    v_exp_f32 v196, v196
    v_exp_f32 v197, v197
    v_exp_f32 v198, v198
    v_exp_f32 v199, v199
    v_fma_f32 v200, v200, s40, -v4
    v_fma_f32 v201, v201, s40, -v4
    v_fma_f32 v202, v202, s40, -v4
    v_fma_f32 v203, v203, s40, -v4
    v_fma_f32 v204, v204, s40, -v4
    v_fma_f32 v205, v205, s40, -v4
    v_fma_f32 v206, v206, s40, -v4
    v_fma_f32 v207, v207, s40, -v4
    v_add_f32 v3, v3, v192
    v_add_f32 v3, v3, v193
    v_add_f32 v3, v3, v194
    v_add_f32 v3, v3, v195
    v_add_f32 v3, v3, v196
    v_add_f32 v3, v3, v197
    v_add_f32 v3, v3, v198
    v_add_f32 v3, v3, v199
    v_cvt_pk_bf16_f32 v80, v192, v193
    v_cvt_pk_bf16_f32 v81, v194, v195
    v_cvt_pk_bf16_f32 v82, v196, v197
    v_cvt_pk_bf16_f32 v83, v198, v199
    v_exp_f32 v200, v200
    v_exp_f32 v201, v201
    v_exp_f32 v202, v202
    v_exp_f32 v203, v203
    v_exp_f32 v204, v204
    v_exp_f32 v205, v205
    v_exp_f32 v206, v206
    v_exp_f32 v207, v207
    v_fma_f32 v208, v208, s40, -v4
    v_fma_f32 v209, v209, s40, -v4
    v_fma_f32 v210, v210, s40, -v4
    v_fma_f32 v211, v211, s40, -v4
    v_fma_f32 v212, v212, s40, -v4
    v_fma_f32 v213, v213, s40, -v4
    v_fma_f32 v214, v214, s40, -v4
    v_fma_f32 v215, v215, s40, -v4
    v_add_f32 v3, v3, v200
    v_add_f32 v3, v3, v201
    v_add_f32 v3, v3, v202
    v_add_f32 v3, v3, v203
    v_add_f32 v3, v3, v204
    v_add_f32 v3, v3, v205
    v_add_f32 v3, v3, v206
    v_add_f32 v3, v3, v207
    v_cvt_pk_bf16_f32 v84, v200, v201
    v_cvt_pk_bf16_f32 v85, v202, v203
    v_cvt_pk_bf16_f32 v86, v204, v205
    v_cvt_pk_bf16_f32 v87, v206, v207
    v_exp_f32 v208, v208
    v_exp_f32 v209, v209
    v_exp_f32 v210, v210
    v_exp_f32 v211, v211
    v_exp_f32 v212, v212
    v_exp_f32 v213, v213
    v_exp_f32 v214, v214
    v_exp_f32 v215, v215
    v_fma_f32 v216, v216, s40, -v4
    v_fma_f32 v217, v217, s40, -v4
    v_fma_f32 v218, v218, s40, -v4
    v_fma_f32 v219, v219, s40, -v4
    v_fma_f32 v220, v220, s40, -v4
    v_fma_f32 v221, v221, s40, -v4
    v_fma_f32 v222, v222, s40, -v4
    v_fma_f32 v223, v223, s40, -v4
    v_add_f32 v3, v3, v208
    v_add_f32 v3, v3, v209
    v_add_f32 v3, v3, v210
    v_add_f32 v3, v3, v211
    v_add_f32 v3, v3, v212
    v_add_f32 v3, v3, v213
    v_add_f32 v3, v3, v214
    v_add_f32 v3, v3, v215
    v_cvt_pk_bf16_f32 v88, v208, v209
    v_cvt_pk_bf16_f32 v89, v210, v211
    v_cvt_pk_bf16_f32 v90, v212, v213
    v_cvt_pk_bf16_f32 v91, v214, v215
    v_exp_f32 v216, v216
    v_exp_f32 v217, v217
    v_exp_f32 v218, v218
    v_exp_f32 v219, v219
    v_exp_f32 v220, v220
    v_exp_f32 v221, v221
    v_exp_f32 v222, v222
    v_exp_f32 v223, v223
    s_nop 0
    v_add_f32 v3, v3, v216
    v_add_f32 v3, v3, v217
    v_add_f32 v3, v3, v218
    v_add_f32 v3, v3, v219
    v_add_f32 v3, v3, v220
    v_add_f32 v3, v3, v221
    v_add_f32 v3, v3, v222
    v_add_f32 v3, v3, v223
    v_cvt_pk_bf16_f32 v92, v216, v217
    v_cvt_pk_bf16_f32 v93, v218, v219
    v_cvt_pk_bf16_f32 v94, v220, v221
    v_cvt_pk_bf16_f32 v95, v222, v223
attnb_pv1:
    ds_read_b128 v[160:163], v9 offset:0
    ds_read_b128 v[164:167], v9 offset:1024
    ds_read_b128 v[168:171], v9 offset:2048
    ds_read_b128 v[172:175], v9 offset:3072
    ds_read_b128 v[176:179], v9 offset:4096
    ds_read_b128 v[180:183], v9 offset:5120
    ds_read_b128 v[184:187], v9 offset:6144
    s_waitcnt lgkmcnt(6)
    v_mfma_f32_32x32x16_bf16 v[96:111], v[160:163], v[80:83], v[96:111]
    ds_read_b128 v[188:191], v9 offset:7168
    s_waitcnt lgkmcnt(6)
    v_mfma_f32_32x32x16_bf16 v[112:127], v[164:167], v[80:83], v[112:127]
    ds_read_b128 v[160:163], v9 offset:8192
    s_waitcnt lgkmcnt(6)
    v_mfma_f32_32x32x16_bf16 v[128:143], v[168:171], v[80:83], v[128:143]
    ds_read_b128 v[164:167], v9 offset:9216
    s_waitcnt lgkmcnt(6)
    v_mfma_f32_32x32x16_bf16 v[144:159], v[172:175], v[80:83], v[144:159]
    ds_read_b128 v[168:171], v9 offset:10240
    s_waitcnt lgkmcnt(6)
    v_mfma_f32_32x32x16_bf16 v[96:111], v[176:179], v[84:87], v[96:111]
    ds_read_b128 v[172:175], v9 offset:11264
    s_waitcnt lgkmcnt(6)
    v_mfma_f32_32x32x16_bf16 v[112:127], v[180:183], v[84:87], v[112:127]
    ds_read_b128 v[176:179], v9 offset:12288
    s_waitcnt lgkmcnt(6)
    v_mfma_f32_32x32x16_bf16 v[128:143], v[184:187], v[84:87], v[128:143]
    ds_read_b128 v[180:183], v9 offset:13312
    s_waitcnt lgkmcnt(6)
    v_mfma_f32_32x32x16_bf16 v[144:159], v[188:191], v[84:87], v[144:159]
    ds_read_b128 v[184:187], v9 offset:14336
    s_waitcnt lgkmcnt(6)
    v_mfma_f32_32x32x16_bf16 v[96:111], v[160:163], v[88:91], v[96:111]
    ds_read_b128 v[188:191], v9 offset:15360
    s_waitcnt lgkmcnt(6)
    v_mfma_f32_32x32x16_bf16 v[112:127], v[164:167], v[88:91], v[112:127]
    s_waitcnt lgkmcnt(5)
    v_mfma_f32_32x32x16_bf16 v[128:143], v[168:171], v[88:91], v[128:143]
    s_waitcnt lgkmcnt(4)
    v_mfma_f32_32x32x16_bf16 v[144:159], v[172:175], v[88:91], v[144:159]
    s_waitcnt lgkmcnt(3)
    v_mfma_f32_32x32x16_bf16 v[96:111], v[176:179], v[92:95], v[96:111]
    s_waitcnt lgkmcnt(2)
    v_mfma_f32_32x32x16_bf16 v[112:127], v[180:183], v[92:95], v[112:127]
    s_waitcnt lgkmcnt(1)
    v_mfma_f32_32x32x16_bf16 v[128:143], v[184:187], v[92:95], v[128:143]
    s_waitcnt lgkmcnt(0)
    v_mfma_f32_32x32x16_bf16 v[144:159], v[188:191], v[92:95], v[144:159]
    s_sub_u32 s34, s21, 2
    s_cmp_lt_u32 s32, s34
    s_cbranch_scc1 attnb_m11
    s_nop 15
    s_lshl_b32 s34, s32, 6
    v_subrev_u32 v4, s34, v7
    v_mov_b32 v5, 0xf149f2ca
    v_cmp_gt_i32 vcc, 0, v4
    s_nop 1
    v_cndmask_b32 v48, v48, v5, vcc
    v_cmp_gt_i32 vcc, 1, v4
    s_nop 1
    v_cndmask_b32 v49, v49, v5, vcc
    v_cmp_gt_i32 vcc, 2, v4
    s_nop 1
    v_cndmask_b32 v50, v50, v5, vcc
    v_cmp_gt_i32 vcc, 3, v4
    s_nop 1
    v_cndmask_b32 v51, v51, v5, vcc
    v_cmp_gt_i32 vcc, 8, v4
    s_nop 1
    v_cndmask_b32 v52, v52, v5, vcc
    v_cmp_gt_i32 vcc, 9, v4
    s_nop 1
    v_cndmask_b32 v53, v53, v5, vcc
    v_cmp_gt_i32 vcc, 10, v4
    s_nop 1
    v_cndmask_b32 v54, v54, v5, vcc
    v_cmp_gt_i32 vcc, 11, v4
    s_nop 1
    v_cndmask_b32 v55, v55, v5, vcc
    v_cmp_gt_i32 vcc, 16, v4
    s_nop 1
    v_cndmask_b32 v56, v56, v5, vcc
    v_cmp_gt_i32 vcc, 17, v4
    s_nop 1
    v_cndmask_b32 v57, v57, v5, vcc
    v_cmp_gt_i32 vcc, 18, v4
    s_nop 1
    v_cndmask_b32 v58, v58, v5, vcc
    v_cmp_gt_i32 vcc, 19, v4
    s_nop 1
    v_cndmask_b32 v59, v59, v5, vcc
    v_cmp_gt_i32 vcc, 24, v4
    s_nop 1
    v_cndmask_b32 v60, v60, v5, vcc
    v_cmp_gt_i32 vcc, 25, v4
    s_nop 1
    v_cndmask_b32 v61, v61, v5, vcc
    v_cmp_gt_i32 vcc, 26, v4
    s_nop 1
    v_cndmask_b32 v62, v62, v5, vcc
    v_cmp_gt_i32 vcc, 27, v4
    s_nop 1
    v_cndmask_b32 v63, v63, v5, vcc
    v_cmp_gt_i32 vcc, 32, v4
    s_nop 1
    v_cndmask_b32 v64, v64, v5, vcc
    v_cmp_gt_i32 vcc, 33, v4
    s_nop 1
    v_cndmask_b32 v65, v65, v5, vcc
    v_cmp_gt_i32 vcc, 34, v4
    s_nop 1
    v_cndmask_b32 v66, v66, v5, vcc
    v_cmp_gt_i32 vcc, 35, v4
    s_nop 1
    v_cndmask_b32 v67, v67, v5, vcc
    v_cmp_gt_i32 vcc, 40, v4
    s_nop 1
    v_cndmask_b32 v68, v68, v5, vcc
    v_cmp_gt_i32 vcc, 41, v4
    s_nop 1
    v_cndmask_b32 v69, v69, v5, vcc
    v_cmp_gt_i32 vcc, 42, v4
    s_nop 1
    v_cndmask_b32 v70, v70, v5, vcc
    v_cmp_gt_i32 vcc, 43, v4
    s_nop 1
    v_cndmask_b32 v71, v71, v5, vcc
    v_cmp_gt_i32 vcc, 48, v4
    s_nop 1
    v_cndmask_b32 v72, v72, v5, vcc
    v_cmp_gt_i32 vcc, 49, v4
    s_nop 1
    v_cndmask_b32 v73, v73, v5, vcc
    v_cmp_gt_i32 vcc, 50, v4
    s_nop 1
    v_cndmask_b32 v74, v74, v5, vcc
    v_cmp_gt_i32 vcc, 51, v4
    s_nop 1
    v_cndmask_b32 v75, v75, v5, vcc
    v_cmp_gt_i32 vcc, 56, v4
    s_nop 1
    v_cndmask_b32 v76, v76, v5, vcc
    v_cmp_gt_i32 vcc, 57, v4
    s_nop 1
    v_cndmask_b32 v77, v77, v5, vcc
    v_cmp_gt_i32 vcc, 58, v4
    s_nop 1
    v_cndmask_b32 v78, v78, v5, vcc
    v_cmp_gt_i32 vcc, 59, v4
    s_nop 1
    v_cndmask_b32 v79, v79, v5, vcc
attnb_m11:
    s_waitcnt vmcnt(0) lgkmcnt(0)
    s_barrier
    s_add_u32 s31, s31, 1
    s_cmp_ge_u32 s31, s21
    s_cbranch_scc1 attnb_done
    s_branch attnb_loop
attnb_done:
    s_nop 15
    v_mov_b32 v5, v3
    s_nop 1
    v_permlane32_swap_b32 v3, v5
    v_add_f32 v3, v3, v5
    v_rcp_f32 v3, v3
    s_nop 0
    s_lshl_b32 s22, s20, 2
    s_add_u32 s22, s22, s16
    s_lshl_b32 s22, s22, 8
    s_lshl_b32 s23, s17, 3
    s_add_u32 s22, s22, s23
    s_lshl_b32 s22, s22, 10
    s_add_u32 s22, s22, 50331648
    s_add_u32 s23, s22, 4096
    v_mul_f32 v96, v96, v3
    v_mul_f32 v97, v97, v3
    v_mul_f32 v98, v98, v3
    v_mul_f32 v99, v99, v3
    v_mul_f32 v100, v100, v3
    v_mul_f32 v101, v101, v3
    v_mul_f32 v102, v102, v3
    v_mul_f32 v103, v103, v3
    v_cvt_pk_bf16_f32 v160, v96, v97
    v_cvt_pk_bf16_f32 v161, v98, v99
    v_cvt_pk_bf16_f32 v162, v100, v101
    v_cvt_pk_bf16_f32 v163, v102, v103
    buffer_store_dwordx4 v[160:163], v8, s[8:11], s22 offen offset:0
    v_mul_f32 v104, v104, v3
    v_mul_f32 v105, v105, v3
    v_mul_f32 v106, v106, v3
    v_mul_f32 v107, v107, v3
    v_mul_f32 v108, v108, v3
    v_mul_f32 v109, v109, v3
    v_mul_f32 v110, v110, v3
    v_mul_f32 v111, v111, v3
    v_cvt_pk_bf16_f32 v164, v104, v105
    v_cvt_pk_bf16_f32 v165, v106, v107
    v_cvt_pk_bf16_f32 v166, v108, v109
    v_cvt_pk_bf16_f32 v167, v110, v111
    buffer_store_dwordx4 v[164:167], v8, s[8:11], s22 offen offset:1024
    v_mul_f32 v112, v112, v3
    v_mul_f32 v113, v113, v3
    v_mul_f32 v114, v114, v3
    v_mul_f32 v115, v115, v3
    v_mul_f32 v116, v116, v3
    v_mul_f32 v117, v117, v3
    v_mul_f32 v118, v118, v3
    v_mul_f32 v119, v119, v3
    v_cvt_pk_bf16_f32 v160, v112, v113
    v_cvt_pk_bf16_f32 v161, v114, v115
    v_cvt_pk_bf16_f32 v162, v116, v117
    v_cvt_pk_bf16_f32 v163, v118, v119
    buffer_store_dwordx4 v[160:163], v8, s[8:11], s22 offen offset:2048
    v_mul_f32 v120, v120, v3
    v_mul_f32 v121, v121, v3
    v_mul_f32 v122, v122, v3
    v_mul_f32 v123, v123, v3
    v_mul_f32 v124, v124, v3
    v_mul_f32 v125, v125, v3
    v_mul_f32 v126, v126, v3
    v_mul_f32 v127, v127, v3
    v_cvt_pk_bf16_f32 v164, v120, v121
    v_cvt_pk_bf16_f32 v165, v122, v123
    v_cvt_pk_bf16_f32 v166, v124, v125
    v_cvt_pk_bf16_f32 v167, v126, v127
    buffer_store_dwordx4 v[164:167], v8, s[8:11], s22 offen offset:3072
    v_mul_f32 v128, v128, v3
    v_mul_f32 v129, v129, v3
    v_mul_f32 v130, v130, v3
    v_mul_f32 v131, v131, v3
    v_mul_f32 v132, v132, v3
    v_mul_f32 v133, v133, v3
    v_mul_f32 v134, v134, v3
    v_mul_f32 v135, v135, v3
    v_cvt_pk_bf16_f32 v160, v128, v129
    v_cvt_pk_bf16_f32 v161, v130, v131
    v_cvt_pk_bf16_f32 v162, v132, v133
    v_cvt_pk_bf16_f32 v163, v134, v135
    buffer_store_dwordx4 v[160:163], v8, s[8:11], s23 offen offset:0
    v_mul_f32 v136, v136, v3
    v_mul_f32 v137, v137, v3
    v_mul_f32 v138, v138, v3
    v_mul_f32 v139, v139, v3
    v_mul_f32 v140, v140, v3
    v_mul_f32 v141, v141, v3
    v_mul_f32 v142, v142, v3
    v_mul_f32 v143, v143, v3
    v_cvt_pk_bf16_f32 v164, v136, v137
    v_cvt_pk_bf16_f32 v165, v138, v139
    v_cvt_pk_bf16_f32 v166, v140, v141
    v_cvt_pk_bf16_f32 v167, v142, v143
    buffer_store_dwordx4 v[164:167], v8, s[8:11], s23 offen offset:1024
    v_mul_f32 v144, v144, v3
    v_mul_f32 v145, v145, v3
    v_mul_f32 v146, v146, v3
    v_mul_f32 v147, v147, v3
    v_mul_f32 v148, v148, v3
    v_mul_f32 v149, v149, v3
    v_mul_f32 v150, v150, v3
    v_mul_f32 v151, v151, v3
    v_cvt_pk_bf16_f32 v160, v144, v145
    v_cvt_pk_bf16_f32 v161, v146, v147
    v_cvt_pk_bf16_f32 v162, v148, v149
    v_cvt_pk_bf16_f32 v163, v150, v151
    buffer_store_dwordx4 v[160:163], v8, s[8:11], s23 offen offset:2048
    v_mul_f32 v152, v152, v3
    v_mul_f32 v153, v153, v3
    v_mul_f32 v154, v154, v3
    v_mul_f32 v155, v155, v3
    v_mul_f32 v156, v156, v3
    v_mul_f32 v157, v157, v3
    v_mul_f32 v158, v158, v3
    v_mul_f32 v159, v159, v3
    v_cvt_pk_bf16_f32 v164, v152, v153
    v_cvt_pk_bf16_f32 v165, v154, v155
    v_cvt_pk_bf16_f32 v166, v156, v157
    v_cvt_pk_bf16_f32 v167, v158, v159
    buffer_store_dwordx4 v[164:167], v8, s[8:11], s23 offen offset:3072
    s_add_u32 s19, s19, 1
    s_cmp_lt_u32 s19, 2
    s_cbranch_scc1 attnb_pass
attnb_exit:
    s_endpgm
attna_entry:
    s_sub_u32 s2, s2, 256
    s_cmp_ge_u32 s2, 512
    s_cbranch_scc1 attna_exit
    s_load_dwordx2 s[4:5], s[0:1], 104
    v_lshrrev_b32 v1, 6, v0
    v_and_b32 v0, 63, v0
    s_nop 0
    v_readfirstlane_b32 s16, v1
    s_waitcnt lgkmcnt(0)
    s_mov_b32 s8, s4
    s_and_b32 s9, s5, 0xffff
    s_mov_b32 s10, 268435456
    s_mov_b32 s11, 0x00020000
    s_lshr_b32 s17, s2, 3
    s_and_b32 s18, s2, 7
    s_lshl_b32 s18, s18, 2
    s_add_u32 s18, s18, s16
    v_lshlrev_b32 v6, 4, v0
    s_mov_b32 s40, 0x3eb8aa3b
    s_lshl_b32 s22, s17, 5
    s_add_u32 s22, s22, s18
    s_lshl_b32 s22, s22, 10
    s_add_u32 s23, s22, 67108864
    buffer_load_dwordx4 v[12:15], v6, s[8:11], s23 offen
    v_and_b32 v7, 31, v0
    v_cmp_eq_u32 vcc, 16, v7
    v_mov_b32 v8, 0x3f803f80
    s_nop 1
    v_cndmask_b32 v8, 0, v8, vcc
    v_mov_b32 v88, v8
    v_mov_b32 v89, v8
    v_mov_b32 v90, v8
    v_mov_b32 v91, v8
    v_mov_b32 v92, v8
    v_mov_b32 v93, v8
    v_mov_b32 v94, v8
    v_mov_b32 v95, v8
    v_mov_b32 v96, v8
    v_mov_b32 v97, v8
    v_mov_b32 v98, v8
    v_mov_b32 v99, v8
    v_mov_b32 v100, v8
    v_mov_b32 v101, v8
    v_mov_b32 v102, v8
    v_mov_b32 v103, v8
    v_mov_b32 v2, 0xf149f2ca
    v_mov_b32 v64, 0
    v_mov_b32 v65, 0
    v_mov_b32 v66, 0
    v_mov_b32 v67, 0
    v_mov_b32 v68, 0
    v_mov_b32 v69, 0
    v_mov_b32 v70, 0
    v_mov_b32 v71, 0
    v_mov_b32 v72, 0
    v_mov_b32 v73, 0
    v_mov_b32 v74, 0
    v_mov_b32 v75, 0
    v_mov_b32 v76, 0
    v_mov_b32 v77, 0
    v_mov_b32 v78, 0
    v_mov_b32 v79, 0
    s_mov_b32 s42, 0x0000ffff
    s_mov_b32 s43, 0x0000ffff
    s_lshl_b32 s24, s16, 11
    s_add_u32 s24, s24, 71303168
    s_lshl_b32 s25, s16, 12
    s_add_u32 s25, s25, 72351744
    s_mov_b32 s28, 0
    s_mov_b32 s29, 24576
    s_lshl_b32 s30, s16, 11
    s_add_u32 s30, s30, s28
    s_mov_b32 m0, s30
    s_lshl_b32 s30, s16, 12
    buffer_load_dwordx4 v6, s[8:11], s24 offen lds
    buffer_load_dwordx4 v6, s[8:11], s24 offen offset:1024 lds
    s_add_u32 s30, s30, s28
    s_add_u32 s30, s30, 8192
    s_mov_b32 m0, s30
    s_add_u32 s24, s24, 8192
    buffer_load_dwordx4 v6, s[8:11], s25 offen offset:0 lds
    buffer_load_dwordx4 v6, s[8:11], s25 offen offset:1024 lds
    buffer_load_dwordx4 v6, s[8:11], s25 offen offset:2048 lds
    buffer_load_dwordx4 v6, s[8:11], s25 offen offset:3072 lds
    s_add_u32 s25, s25, 16384
    s_mov_b32 s31, 0
    s_waitcnt vmcnt(0)
    s_barrier
attna_loop:
    s_cmp_ge_u32 s31, 7
    s_cbranch_scc1 attna_nodma
    s_lshl_b32 s30, s16, 11
    s_add_u32 s30, s30, s29
    s_mov_b32 m0, s30
    s_lshl_b32 s30, s16, 12
    buffer_load_dwordx4 v6, s[8:11], s24 offen lds
    buffer_load_dwordx4 v6, s[8:11], s24 offen offset:1024 lds
    s_add_u32 s30, s30, s29
    s_add_u32 s30, s30, 8192
    s_mov_b32 m0, s30
    s_add_u32 s24, s24, 8192
    buffer_load_dwordx4 v6, s[8:11], s25 offen offset:0 lds
    buffer_load_dwordx4 v6, s[8:11], s25 offen offset:1024 lds
    buffer_load_dwordx4 v6, s[8:11], s25 offen offset:2048 lds
    buffer_load_dwordx4 v6, s[8:11], s25 offen offset:3072 lds
    s_add_u32 s25, s25, 16384
attna_nodma:
    v_add_u32 v5, s28, v6
    ds_read_b128 v[80:83], v5 offset:0
    ds_read_b128 v[84:87], v5 offset:1024
    s_mov_b64 exec, s[42:43]
    ds_read_b128 v[88:91], v5 offset:8192
    ds_read_b128 v[92:95], v5 offset:9216
    ds_read_b128 v[96:99], v5 offset:10240
    ds_read_b128 v[100:103], v5 offset:11264
    s_mov_b64 exec, -1
    s_waitcnt lgkmcnt(5)
    v_mfma_f32_32x32x16_bf16 v[16:31], v[80:83], v[12:15], 0
    s_waitcnt lgkmcnt(4)
    v_mfma_f32_32x32x16_bf16 v[32:47], v[84:87], v[12:15], 0
    s_nop 15
    v_max3_f32 v3, v16, v17, v18
    v_max3_f32 v3, v3, v19, v20
    v_max3_f32 v3, v3, v21, v22
    v_max3_f32 v3, v3, v23, v24
    v_max3_f32 v3, v3, v25, v26
    v_max3_f32 v3, v3, v27, v28
    v_max3_f32 v3, v3, v29, v30
    v_max3_f32 v3, v3, v31, v32
    v_max3_f32 v3, v3, v33, v34
    v_max3_f32 v3, v3, v35, v36
    v_max3_f32 v3, v3, v37, v38
    v_max3_f32 v3, v3, v39, v40
    v_max3_f32 v3, v3, v41, v42
    v_max3_f32 v3, v3, v43, v44
    v_max3_f32 v3, v3, v45, v46
    v_max_f32 v3, v3, v47
    v_mov_b32 v4, v3
    s_nop 1
    v_permlane32_swap_b32 v3, v4
    v_max3_f32 v3, v3, v4, v2
    v_sub_f32 v4, v2, v3
    v_mul_f32 v4, s40, v4
    v_exp_f32 v4, v4
    v_mov_b32 v2, v3
    v_mul_f32 v3, s40, v3
    v_mul_f32 v64, v64, v4
    v_mul_f32 v65, v65, v4
    v_mul_f32 v66, v66, v4
    v_mul_f32 v67, v67, v4
    v_mul_f32 v68, v68, v4
    v_mul_f32 v69, v69, v4
    v_mul_f32 v70, v70, v4
    v_mul_f32 v71, v71, v4
    v_mul_f32 v72, v72, v4
    v_mul_f32 v73, v73, v4
    v_mul_f32 v74, v74, v4
    v_mul_f32 v75, v75, v4
    v_mul_f32 v76, v76, v4
    v_mul_f32 v77, v77, v4
    v_mul_f32 v78, v78, v4
    v_mul_f32 v79, v79, v4
    v_fma_f32 v16, v16, s40, -v3
    v_fma_f32 v17, v17, s40, -v3
    v_fma_f32 v18, v18, s40, -v3
    v_fma_f32 v19, v19, s40, -v3
    v_fma_f32 v20, v20, s40, -v3
    v_fma_f32 v21, v21, s40, -v3
    v_fma_f32 v22, v22, s40, -v3
    v_fma_f32 v23, v23, s40, -v3
    v_fma_f32 v24, v24, s40, -v3
    v_fma_f32 v25, v25, s40, -v3
    v_fma_f32 v26, v26, s40, -v3
    v_fma_f32 v27, v27, s40, -v3
    v_fma_f32 v28, v28, s40, -v3
    v_fma_f32 v29, v29, s40, -v3
    v_fma_f32 v30, v30, s40, -v3
    v_fma_f32 v31, v31, s40, -v3
    v_fma_f32 v32, v32, s40, -v3
    v_fma_f32 v33, v33, s40, -v3
    v_fma_f32 v34, v34, s40, -v3
    v_fma_f32 v35, v35, s40, -v3
    v_fma_f32 v36, v36, s40, -v3
    v_fma_f32 v37, v37, s40, -v3
    v_fma_f32 v38, v38, s40, -v3
    v_fma_f32 v39, v39, s40, -v3
    v_fma_f32 v40, v40, s40, -v3
    v_fma_f32 v41, v41, s40, -v3
    v_fma_f32 v42, v42, s40, -v3
    v_fma_f32 v43, v43, s40, -v3
    v_fma_f32 v44, v44, s40, -v3
    v_fma_f32 v45, v45, s40, -v3
    v_fma_f32 v46, v46, s40, -v3
    v_fma_f32 v47, v47, s40, -v3
    v_exp_f32 v16, v16
    v_exp_f32 v17, v17
    v_exp_f32 v18, v18
    v_exp_f32 v19, v19
    v_exp_f32 v20, v20
    v_exp_f32 v21, v21
    v_exp_f32 v22, v22
    v_exp_f32 v23, v23
    v_exp_f32 v24, v24
    v_exp_f32 v25, v25
    v_exp_f32 v26, v26
    v_exp_f32 v27, v27
    v_exp_f32 v28, v28
    v_exp_f32 v29, v29
    v_exp_f32 v30, v30
    v_exp_f32 v31, v31
    v_exp_f32 v32, v32
    v_exp_f32 v33, v33
    v_exp_f32 v34, v34
    v_exp_f32 v35, v35
    v_exp_f32 v36, v36
    v_exp_f32 v37, v37
    v_exp_f32 v38, v38
    v_exp_f32 v39, v39
    v_exp_f32 v40, v40
    v_exp_f32 v41, v41
    v_exp_f32 v42, v42
    v_exp_f32 v43, v43
    v_exp_f32 v44, v44
    v_exp_f32 v45, v45
    v_exp_f32 v46, v46
    v_exp_f32 v47, v47
    s_nop 0
    v_cvt_pk_bf16_f32 v48, v16, v17
    v_cvt_pk_bf16_f32 v49, v18, v19
    v_cvt_pk_bf16_f32 v50, v20, v21
    v_cvt_pk_bf16_f32 v51, v22, v23
    v_cvt_pk_bf16_f32 v52, v24, v25
    v_cvt_pk_bf16_f32 v53, v26, v27
    v_cvt_pk_bf16_f32 v54, v28, v29
    v_cvt_pk_bf16_f32 v55, v30, v31
    v_cvt_pk_bf16_f32 v56, v32, v33
    v_cvt_pk_bf16_f32 v57, v34, v35
    v_cvt_pk_bf16_f32 v58, v36, v37
    v_cvt_pk_bf16_f32 v59, v38, v39
    v_cvt_pk_bf16_f32 v60, v40, v41
    v_cvt_pk_bf16_f32 v61, v42, v43
    v_cvt_pk_bf16_f32 v62, v44, v45
    v_cvt_pk_bf16_f32 v63, v46, v47
    s_waitcnt lgkmcnt(0)
    v_mfma_f32_32x32x16_bf16 v[64:79], v[88:91], v[48:51], v[64:79]
    v_mfma_f32_32x32x16_bf16 v[64:79], v[92:95], v[52:55], v[64:79]
    v_mfma_f32_32x32x16_bf16 v[64:79], v[96:99], v[56:59], v[64:79]
    v_mfma_f32_32x32x16_bf16 v[64:79], v[100:103], v[60:63], v[64:79]
    s_nop 7
    s_nop 7
    ds_read_b128 v[80:83], v5 offset:2048
    ds_read_b128 v[84:87], v5 offset:3072
    s_mov_b64 exec, s[42:43]
    ds_read_b128 v[88:91], v5 offset:12288
    ds_read_b128 v[92:95], v5 offset:13312
    ds_read_b128 v[96:99], v5 offset:14336
    ds_read_b128 v[100:103], v5 offset:15360
    s_mov_b64 exec, -1
    s_waitcnt lgkmcnt(5)
    v_mfma_f32_32x32x16_bf16 v[16:31], v[80:83], v[12:15], 0
    s_waitcnt lgkmcnt(4)
    v_mfma_f32_32x32x16_bf16 v[32:47], v[84:87], v[12:15], 0
    s_nop 15
    v_max3_f32 v3, v16, v17, v18
    v_max3_f32 v3, v3, v19, v20
    v_max3_f32 v3, v3, v21, v22
    v_max3_f32 v3, v3, v23, v24
    v_max3_f32 v3, v3, v25, v26
    v_max3_f32 v3, v3, v27, v28
    v_max3_f32 v3, v3, v29, v30
    v_max3_f32 v3, v3, v31, v32
    v_max3_f32 v3, v3, v33, v34
    v_max3_f32 v3, v3, v35, v36
    v_max3_f32 v3, v3, v37, v38
    v_max3_f32 v3, v3, v39, v40
    v_max3_f32 v3, v3, v41, v42
    v_max3_f32 v3, v3, v43, v44
    v_max3_f32 v3, v3, v45, v46
    v_max_f32 v3, v3, v47
    v_mov_b32 v4, v3
    s_nop 1
    v_permlane32_swap_b32 v3, v4
    v_max3_f32 v3, v3, v4, v2
    v_sub_f32 v4, v2, v3
    v_mul_f32 v4, s40, v4
    v_exp_f32 v4, v4
    v_mov_b32 v2, v3
    v_mul_f32 v3, s40, v3
    v_mul_f32 v64, v64, v4
    v_mul_f32 v65, v65, v4
    v_mul_f32 v66, v66, v4
    v_mul_f32 v67, v67, v4
    v_mul_f32 v68, v68, v4
    v_mul_f32 v69, v69, v4
    v_mul_f32 v70, v70, v4
    v_mul_f32 v71, v71, v4
    v_mul_f32 v72, v72, v4
    v_mul_f32 v73, v73, v4
    v_mul_f32 v74, v74, v4
    v_mul_f32 v75, v75, v4
    v_mul_f32 v76, v76, v4
    v_mul_f32 v77, v77, v4
    v_mul_f32 v78, v78, v4
    v_mul_f32 v79, v79, v4
    v_fma_f32 v16, v16, s40, -v3
    v_fma_f32 v17, v17, s40, -v3
    v_fma_f32 v18, v18, s40, -v3
    v_fma_f32 v19, v19, s40, -v3
    v_fma_f32 v20, v20, s40, -v3
    v_fma_f32 v21, v21, s40, -v3
    v_fma_f32 v22, v22, s40, -v3
    v_fma_f32 v23, v23, s40, -v3
    v_fma_f32 v24, v24, s40, -v3
    v_fma_f32 v25, v25, s40, -v3
    v_fma_f32 v26, v26, s40, -v3
    v_fma_f32 v27, v27, s40, -v3
    v_fma_f32 v28, v28, s40, -v3
    v_fma_f32 v29, v29, s40, -v3
    v_fma_f32 v30, v30, s40, -v3
    v_fma_f32 v31, v31, s40, -v3
    v_fma_f32 v32, v32, s40, -v3
    v_fma_f32 v33, v33, s40, -v3
    v_fma_f32 v34, v34, s40, -v3
    v_fma_f32 v35, v35, s40, -v3
    v_fma_f32 v36, v36, s40, -v3
    v_fma_f32 v37, v37, s40, -v3
    v_fma_f32 v38, v38, s40, -v3
    v_fma_f32 v39, v39, s40, -v3
    v_fma_f32 v40, v40, s40, -v3
    v_fma_f32 v41, v41, s40, -v3
    v_fma_f32 v42, v42, s40, -v3
    v_fma_f32 v43, v43, s40, -v3
    v_fma_f32 v44, v44, s40, -v3
    v_fma_f32 v45, v45, s40, -v3
    v_fma_f32 v46, v46, s40, -v3
    v_fma_f32 v47, v47, s40, -v3
    v_exp_f32 v16, v16
    v_exp_f32 v17, v17
    v_exp_f32 v18, v18
    v_exp_f32 v19, v19
    v_exp_f32 v20, v20
    v_exp_f32 v21, v21
    v_exp_f32 v22, v22
    v_exp_f32 v23, v23
    v_exp_f32 v24, v24
    v_exp_f32 v25, v25
    v_exp_f32 v26, v26
    v_exp_f32 v27, v27
    v_exp_f32 v28, v28
    v_exp_f32 v29, v29
    v_exp_f32 v30, v30
    v_exp_f32 v31, v31
    v_exp_f32 v32, v32
    v_exp_f32 v33, v33
    v_exp_f32 v34, v34
    v_exp_f32 v35, v35
    v_exp_f32 v36, v36
    v_exp_f32 v37, v37
    v_exp_f32 v38, v38
    v_exp_f32 v39, v39
    v_exp_f32 v40, v40
    v_exp_f32 v41, v41
    v_exp_f32 v42, v42
    v_exp_f32 v43, v43
    v_exp_f32 v44, v44
    v_exp_f32 v45, v45
    v_exp_f32 v46, v46
    v_exp_f32 v47, v47
    s_nop 0
    v_cvt_pk_bf16_f32 v48, v16, v17
    v_cvt_pk_bf16_f32 v49, v18, v19
    v_cvt_pk_bf16_f32 v50, v20, v21
    v_cvt_pk_bf16_f32 v51, v22, v23
    v_cvt_pk_bf16_f32 v52, v24, v25
    v_cvt_pk_bf16_f32 v53, v26, v27
    v_cvt_pk_bf16_f32 v54, v28, v29
    v_cvt_pk_bf16_f32 v55, v30, v31
    v_cvt_pk_bf16_f32 v56, v32, v33
    v_cvt_pk_bf16_f32 v57, v34, v35
    v_cvt_pk_bf16_f32 v58, v36, v37
    v_cvt_pk_bf16_f32 v59, v38, v39
    v_cvt_pk_bf16_f32 v60, v40, v41
    v_cvt_pk_bf16_f32 v61, v42, v43
    v_cvt_pk_bf16_f32 v62, v44, v45
    v_cvt_pk_bf16_f32 v63, v46, v47
    s_waitcnt lgkmcnt(0)
    v_mfma_f32_32x32x16_bf16 v[64:79], v[88:91], v[48:51], v[64:79]
    v_mfma_f32_32x32x16_bf16 v[64:79], v[92:95], v[52:55], v[64:79]
    v_mfma_f32_32x32x16_bf16 v[64:79], v[96:99], v[56:59], v[64:79]
    v_mfma_f32_32x32x16_bf16 v[64:79], v[100:103], v[60:63], v[64:79]
    s_nop 7
    s_nop 7
    ds_read_b128 v[80:83], v5 offset:4096
    ds_read_b128 v[84:87], v5 offset:5120
    s_mov_b64 exec, s[42:43]
    ds_read_b128 v[88:91], v5 offset:16384
    ds_read_b128 v[92:95], v5 offset:17408
    ds_read_b128 v[96:99], v5 offset:18432
    ds_read_b128 v[100:103], v5 offset:19456
    s_mov_b64 exec, -1
    s_waitcnt lgkmcnt(5)
    v_mfma_f32_32x32x16_bf16 v[16:31], v[80:83], v[12:15], 0
    s_waitcnt lgkmcnt(4)
    v_mfma_f32_32x32x16_bf16 v[32:47], v[84:87], v[12:15], 0
    s_nop 15
    v_max3_f32 v3, v16, v17, v18
    v_max3_f32 v3, v3, v19, v20
    v_max3_f32 v3, v3, v21, v22
    v_max3_f32 v3, v3, v23, v24
    v_max3_f32 v3, v3, v25, v26
    v_max3_f32 v3, v3, v27, v28
    v_max3_f32 v3, v3, v29, v30
    v_max3_f32 v3, v3, v31, v32
    v_max3_f32 v3, v3, v33, v34
    v_max3_f32 v3, v3, v35, v36
    v_max3_f32 v3, v3, v37, v38
    v_max3_f32 v3, v3, v39, v40
    v_max3_f32 v3, v3, v41, v42
    v_max3_f32 v3, v3, v43, v44
    v_max3_f32 v3, v3, v45, v46
    v_max_f32 v3, v3, v47
    v_mov_b32 v4, v3
    s_nop 1
    v_permlane32_swap_b32 v3, v4
    v_max3_f32 v3, v3, v4, v2
    v_sub_f32 v4, v2, v3
    v_mul_f32 v4, s40, v4
    v_exp_f32 v4, v4
    v_mov_b32 v2, v3
    v_mul_f32 v3, s40, v3
    v_mul_f32 v64, v64, v4
    v_mul_f32 v65, v65, v4
    v_mul_f32 v66, v66, v4
    v_mul_f32 v67, v67, v4
    v_mul_f32 v68, v68, v4
    v_mul_f32 v69, v69, v4
    v_mul_f32 v70, v70, v4
    v_mul_f32 v71, v71, v4
    v_mul_f32 v72, v72, v4
    v_mul_f32 v73, v73, v4
    v_mul_f32 v74, v74, v4
    v_mul_f32 v75, v75, v4
    v_mul_f32 v76, v76, v4
    v_mul_f32 v77, v77, v4
    v_mul_f32 v78, v78, v4
    v_mul_f32 v79, v79, v4
    v_fma_f32 v16, v16, s40, -v3
    v_fma_f32 v17, v17, s40, -v3
    v_fma_f32 v18, v18, s40, -v3
    v_fma_f32 v19, v19, s40, -v3
    v_fma_f32 v20, v20, s40, -v3
    v_fma_f32 v21, v21, s40, -v3
    v_fma_f32 v22, v22, s40, -v3
    v_fma_f32 v23, v23, s40, -v3
    v_fma_f32 v24, v24, s40, -v3
    v_fma_f32 v25, v25, s40, -v3
    v_fma_f32 v26, v26, s40, -v3
    v_fma_f32 v27, v27, s40, -v3
    v_fma_f32 v28, v28, s40, -v3
    v_fma_f32 v29, v29, s40, -v3
    v_fma_f32 v30, v30, s40, -v3
    v_fma_f32 v31, v31, s40, -v3
    v_fma_f32 v32, v32, s40, -v3
    v_fma_f32 v33, v33, s40, -v3
    v_fma_f32 v34, v34, s40, -v3
    v_fma_f32 v35, v35, s40, -v3
    v_fma_f32 v36, v36, s40, -v3
    v_fma_f32 v37, v37, s40, -v3
    v_fma_f32 v38, v38, s40, -v3
    v_fma_f32 v39, v39, s40, -v3
    v_fma_f32 v40, v40, s40, -v3
    v_fma_f32 v41, v41, s40, -v3
    v_fma_f32 v42, v42, s40, -v3
    v_fma_f32 v43, v43, s40, -v3
    v_fma_f32 v44, v44, s40, -v3
    v_fma_f32 v45, v45, s40, -v3
    v_fma_f32 v46, v46, s40, -v3
    v_fma_f32 v47, v47, s40, -v3
    v_exp_f32 v16, v16
    v_exp_f32 v17, v17
    v_exp_f32 v18, v18
    v_exp_f32 v19, v19
    v_exp_f32 v20, v20
    v_exp_f32 v21, v21
    v_exp_f32 v22, v22
    v_exp_f32 v23, v23
    v_exp_f32 v24, v24
    v_exp_f32 v25, v25
    v_exp_f32 v26, v26
    v_exp_f32 v27, v27
    v_exp_f32 v28, v28
    v_exp_f32 v29, v29
    v_exp_f32 v30, v30
    v_exp_f32 v31, v31
    v_exp_f32 v32, v32
    v_exp_f32 v33, v33
    v_exp_f32 v34, v34
    v_exp_f32 v35, v35
    v_exp_f32 v36, v36
    v_exp_f32 v37, v37
    v_exp_f32 v38, v38
    v_exp_f32 v39, v39
    v_exp_f32 v40, v40
    v_exp_f32 v41, v41
    v_exp_f32 v42, v42
    v_exp_f32 v43, v43
    v_exp_f32 v44, v44
    v_exp_f32 v45, v45
    v_exp_f32 v46, v46
    v_exp_f32 v47, v47
    s_nop 0
    v_cvt_pk_bf16_f32 v48, v16, v17
    v_cvt_pk_bf16_f32 v49, v18, v19
    v_cvt_pk_bf16_f32 v50, v20, v21
    v_cvt_pk_bf16_f32 v51, v22, v23
    v_cvt_pk_bf16_f32 v52, v24, v25
    v_cvt_pk_bf16_f32 v53, v26, v27
    v_cvt_pk_bf16_f32 v54, v28, v29
    v_cvt_pk_bf16_f32 v55, v30, v31
    v_cvt_pk_bf16_f32 v56, v32, v33
    v_cvt_pk_bf16_f32 v57, v34, v35
    v_cvt_pk_bf16_f32 v58, v36, v37
    v_cvt_pk_bf16_f32 v59, v38, v39
    v_cvt_pk_bf16_f32 v60, v40, v41
    v_cvt_pk_bf16_f32 v61, v42, v43
    v_cvt_pk_bf16_f32 v62, v44, v45
    v_cvt_pk_bf16_f32 v63, v46, v47
    s_waitcnt lgkmcnt(0)
    v_mfma_f32_32x32x16_bf16 v[64:79], v[88:91], v[48:51], v[64:79]
    v_mfma_f32_32x32x16_bf16 v[64:79], v[92:95], v[52:55], v[64:79]
    v_mfma_f32_32x32x16_bf16 v[64:79], v[96:99], v[56:59], v[64:79]
    v_mfma_f32_32x32x16_bf16 v[64:79], v[100:103], v[60:63], v[64:79]
    s_nop 7
    s_nop 7
    ds_read_b128 v[80:83], v5 offset:6144
    ds_read_b128 v[84:87], v5 offset:7168
    s_mov_b64 exec, s[42:43]
    ds_read_b128 v[88:91], v5 offset:20480
    ds_read_b128 v[92:95], v5 offset:21504
    ds_read_b128 v[96:99], v5 offset:22528
    ds_read_b128 v[100:103], v5 offset:23552
    s_mov_b64 exec, -1
    s_waitcnt lgkmcnt(5)
    v_mfma_f32_32x32x16_bf16 v[16:31], v[80:83], v[12:15], 0
    s_waitcnt lgkmcnt(4)
    v_mfma_f32_32x32x16_bf16 v[32:47], v[84:87], v[12:15], 0
    s_nop 15
    v_max3_f32 v3, v16, v17, v18
    v_max3_f32 v3, v3, v19, v20
    v_max3_f32 v3, v3, v21, v22
    v_max3_f32 v3, v3, v23, v24
    v_max3_f32 v3, v3, v25, v26
    v_max3_f32 v3, v3, v27, v28
    v_max3_f32 v3, v3, v29, v30
    v_max3_f32 v3, v3, v31, v32
    v_max3_f32 v3, v3, v33, v34
    v_max3_f32 v3, v3, v35, v36
    v_max3_f32 v3, v3, v37, v38
    v_max3_f32 v3, v3, v39, v40
    v_max3_f32 v3, v3, v41, v42
    v_max3_f32 v3, v3, v43, v44
    v_max3_f32 v3, v3, v45, v46
    v_max_f32 v3, v3, v47
    v_mov_b32 v4, v3
    s_nop 1
    v_permlane32_swap_b32 v3, v4
    v_max3_f32 v3, v3, v4, v2
    v_sub_f32 v4, v2, v3
    v_mul_f32 v4, s40, v4
    v_exp_f32 v4, v4
    v_mov_b32 v2, v3
    v_mul_f32 v3, s40, v3
    v_mul_f32 v64, v64, v4
    v_mul_f32 v65, v65, v4
    v_mul_f32 v66, v66, v4
    v_mul_f32 v67, v67, v4
    v_mul_f32 v68, v68, v4
    v_mul_f32 v69, v69, v4
    v_mul_f32 v70, v70, v4
    v_mul_f32 v71, v71, v4
    v_mul_f32 v72, v72, v4
    v_mul_f32 v73, v73, v4
    v_mul_f32 v74, v74, v4
    v_mul_f32 v75, v75, v4
    v_mul_f32 v76, v76, v4
    v_mul_f32 v77, v77, v4
    v_mul_f32 v78, v78, v4
    v_mul_f32 v79, v79, v4
    v_fma_f32 v16, v16, s40, -v3
    v_fma_f32 v17, v17, s40, -v3
    v_fma_f32 v18, v18, s40, -v3
    v_fma_f32 v19, v19, s40, -v3
    v_fma_f32 v20, v20, s40, -v3
    v_fma_f32 v21, v21, s40, -v3
    v_fma_f32 v22, v22, s40, -v3
    v_fma_f32 v23, v23, s40, -v3
    v_fma_f32 v24, v24, s40, -v3
    v_fma_f32 v25, v25, s40, -v3
    v_fma_f32 v26, v26, s40, -v3
    v_fma_f32 v27, v27, s40, -v3
    v_fma_f32 v28, v28, s40, -v3
    v_fma_f32 v29, v29, s40, -v3
    v_fma_f32 v30, v30, s40, -v3
    v_fma_f32 v31, v31, s40, -v3
    v_fma_f32 v32, v32, s40, -v3
    v_fma_f32 v33, v33, s40, -v3
    v_fma_f32 v34, v34, s40, -v3
    v_fma_f32 v35, v35, s40, -v3
    v_fma_f32 v36, v36, s40, -v3
    v_fma_f32 v37, v37, s40, -v3
    v_fma_f32 v38, v38, s40, -v3
    v_fma_f32 v39, v39, s40, -v3
    v_fma_f32 v40, v40, s40, -v3
    v_fma_f32 v41, v41, s40, -v3
    v_fma_f32 v42, v42, s40, -v3
    v_fma_f32 v43, v43, s40, -v3
    v_fma_f32 v44, v44, s40, -v3
    v_fma_f32 v45, v45, s40, -v3
    v_fma_f32 v46, v46, s40, -v3
    v_fma_f32 v47, v47, s40, -v3
    v_exp_f32 v16, v16
    v_exp_f32 v17, v17
    v_exp_f32 v18, v18
    v_exp_f32 v19, v19
    v_exp_f32 v20, v20
    v_exp_f32 v21, v21
    v_exp_f32 v22, v22
    v_exp_f32 v23, v23
    v_exp_f32 v24, v24
    v_exp_f32 v25, v25
    v_exp_f32 v26, v26
    v_exp_f32 v27, v27
    v_exp_f32 v28, v28
    v_exp_f32 v29, v29
    v_exp_f32 v30, v30
    v_exp_f32 v31, v31
    v_exp_f32 v32, v32
    v_exp_f32 v33, v33
    v_exp_f32 v34, v34
    v_exp_f32 v35, v35
    v_exp_f32 v36, v36
    v_exp_f32 v37, v37
    v_exp_f32 v38, v38
    v_exp_f32 v39, v39
    v_exp_f32 v40, v40
    v_exp_f32 v41, v41
    v_exp_f32 v42, v42
    v_exp_f32 v43, v43
    v_exp_f32 v44, v44
    v_exp_f32 v45, v45
    v_exp_f32 v46, v46
    v_exp_f32 v47, v47
    s_nop 0
    v_cvt_pk_bf16_f32 v48, v16, v17
    v_cvt_pk_bf16_f32 v49, v18, v19
    v_cvt_pk_bf16_f32 v50, v20, v21
    v_cvt_pk_bf16_f32 v51, v22, v23
    v_cvt_pk_bf16_f32 v52, v24, v25
    v_cvt_pk_bf16_f32 v53, v26, v27
    v_cvt_pk_bf16_f32 v54, v28, v29
    v_cvt_pk_bf16_f32 v55, v30, v31
    v_cvt_pk_bf16_f32 v56, v32, v33
    v_cvt_pk_bf16_f32 v57, v34, v35
    v_cvt_pk_bf16_f32 v58, v36, v37
    v_cvt_pk_bf16_f32 v59, v38, v39
    v_cvt_pk_bf16_f32 v60, v40, v41
    v_cvt_pk_bf16_f32 v61, v42, v43
    v_cvt_pk_bf16_f32 v62, v44, v45
    v_cvt_pk_bf16_f32 v63, v46, v47
    s_waitcnt lgkmcnt(0)
    v_mfma_f32_32x32x16_bf16 v[64:79], v[88:91], v[48:51], v[64:79]
    v_mfma_f32_32x32x16_bf16 v[64:79], v[92:95], v[52:55], v[64:79]
    v_mfma_f32_32x32x16_bf16 v[64:79], v[96:99], v[56:59], v[64:79]
    v_mfma_f32_32x32x16_bf16 v[64:79], v[100:103], v[60:63], v[64:79]
    s_nop 7
    s_nop 7
    s_waitcnt vmcnt(0) lgkmcnt(0)
    s_barrier
    s_mov_b32 s30, s28
    s_mov_b32 s28, s29
    s_mov_b32 s29, s30
    s_add_u32 s31, s31, 1
    s_cmp_lt_u32 s31, 8
    s_cbranch_scc1 attna_loop
    v_mov_b32 v3, v72
    v_mov_b32 v4, v72
    s_nop 1
    v_permlane32_swap_b32 v3, v4
    v_rcp_f32 v3, v3
    s_nop 0
    v_mul_f32 v64, v64, v3
    v_mul_f32 v65, v65, v3
    v_mul_f32 v66, v66, v3
    v_mul_f32 v67, v67, v3
    v_mul_f32 v68, v68, v3
    v_mul_f32 v69, v69, v3
    v_mul_f32 v70, v70, v3
    v_mul_f32 v71, v71, v3
    v_cvt_pk_bf16_f32 v48, v64, v65
    v_cvt_pk_bf16_f32 v49, v66, v67
    v_cvt_pk_bf16_f32 v50, v68, v69
    v_cvt_pk_bf16_f32 v51, v70, v71
    s_add_u32 s23, s22, 69206016
    buffer_store_dwordx4 v[48:51], v6, s[8:11], s23 offen
attna_exit:
    s_endpgm
.section .rodata,"a"
.p2align 6
.amdhsa_kernel attnb_kernel
  .amdhsa_next_free_vgpr 224
  .amdhsa_next_free_sgpr 102
  .amdhsa_accum_offset 224
  .amdhsa_group_segment_fixed_size 0
  .amdhsa_kernarg_size 112
  .amdhsa_user_sgpr_count 2
  .amdhsa_user_sgpr_kernarg_segment_ptr 1
  .amdhsa_system_sgpr_workgroup_id_x 1
.end_amdhsa_kernel
.text

.globl oproj_kernel
.p2align 8
.type oproj_kernel,@function
oproj_kernel:
    s_cmp_ge_u32 s2, 512
    s_cbranch_scc1 oproj_exit
    s_load_dwordx2 s[4:5], s[0:1], 32
    s_load_dwordx2 s[6:7], s[0:1], 80
    s_load_dwordx2 s[60:61], s[0:1], 88
    s_load_dwordx2 s[62:63], s[0:1], 104
    v_lshrrev_b32 v1, 6, v0
    v_and_b32 v0, 63, v0
    s_nop 0
    v_readfirstlane_b32 s16, v1
    s_waitcnt lgkmcnt(0)
    s_and_b32 s17, s16, 1
    s_lshr_b32 s18, s16, 1
    s_and_b32 s19, s2, 255
    s_and_b32 s20, s19, 7
    s_lshr_b32 s21, s19, 3
    s_cmp_lt_u32 s2, 256
    s_cbranch_scc1 oproj_jb
    s_mov_b32 s22, 2
    s_mov_b32 s23, 69206016
    s_mov_b32 s24, 32768
    s_mov_b32 s25, 0
    s_mov_b32 s33, 0x80000
    s_branch oproj_go
oproj_jb:
    s_mov_b64 s[4:5], s[6:7]
    s_mov_b32 s22, 16
    s_mov_b32 s23, 50331648
    s_mov_b32 s24, 262144
    s_mov_b32 s25, 1024
    s_mov_b32 s33, 0x400000
oproj_go:
    s_mov_b32 s8, s4
    s_and_b32 s9, s5, 0xffff
    s_mov_b32 s10, s33
    s_mov_b32 s11, 0x00020000
    s_mov_b32 s12, s62
    s_and_b32 s13, s63, 0xffff
    s_mov_b32 s14, 268435456
    s_mov_b32 s15, 0x00020000
    s_mov_b32 s64, s60
    s_and_b32 s65, s61, 0xffff
    s_mov_b32 s66, 4194304
    s_mov_b32 s67, 0x00020000
    v_lshrrev_b32 v12, 5, v0
    v_lshrrev_b32 v14, 4, v0
    v_and_b32 v14, 1, v14
    v_and_b32 v15, 15, v0
    v_lshrrev_b32 v16, 2, v15
    v_and_b32 v17, 3, v15
    v_lshl_add_u32 v18, v12, 2, v16
    v_lshlrev_b32 v18, 7, v18
    v_and_b32 v19, 1, v17
    v_lshl_add_u32 v18, v19, 3, v18
    v_lshrrev_b32 v19, 1, v17
    v_lshl_add_u32 v19, v14, 1, v19
    s_lshl_b32 s30, s17, 2
    v_add_u32 v19, s30, v19
    v_lshlrev_b32 v20, 1, v16
    v_xor_b32 v19, v19, v20
    v_lshl_add_u32 v2, v19, 4, v18
    v_lshrrev_b32 v14, 3, v0
    v_and_b32 v15, 7, v0
    v_and_b32 v16, 3, v14
    v_lshlrev_b32 v16, 1, v16
    v_xor_b32 v15, v15, v16
    v_lshlrev_b32 v15, 4, v15
    v_lshl_add_u32 v3, v14, 10, v15
    v_lshlrev_b32 v4, 4, v0
    s_lshl_b32 s26, s16, 16
    s_lshl_b32 s30, s20, 7
    s_add_u32 s26, s26, s30
    s_lshl_b32 s30, s21, 1
    s_add_u32 s30, s30, s18
    s_mul_i32 s30, s30, s24
    s_add_u32 s23, s23, s30
    v_mov_b32 v48, 0
    v_mov_b32 v49, 0
    v_mov_b32 v50, 0
    v_mov_b32 v51, 0
    v_mov_b32 v52, 0
    v_mov_b32 v53, 0
    v_mov_b32 v54, 0
    v_mov_b32 v55, 0
    v_mov_b32 v56, 0
    v_mov_b32 v57, 0
    v_mov_b32 v58, 0
    v_mov_b32 v59, 0
    v_mov_b32 v60, 0
    v_mov_b32 v61, 0
    v_mov_b32 v62, 0
    v_mov_b32 v63, 0
    s_lshl_b32 s30, s16, 13
    s_add_u32 s30, s30, 0
    s_mov_b32 m0, s30
    s_mov_b32 s31, s26
    buffer_load_dwordx4 v3, s[8:11], s31 offen lds
    s_add_u32 m0, m0, 1024
    s_add_u32 s31, s31, 8192
    buffer_load_dwordx4 v3, s[8:11], s31 offen lds
    s_add_u32 m0, m0, 1024
    s_add_u32 s31, s31, 8192
    buffer_load_dwordx4 v3, s[8:11], s31 offen lds
    s_add_u32 m0, m0, 1024
    s_add_u32 s31, s31, 8192
    buffer_load_dwordx4 v3, s[8:11], s31 offen lds
    s_add_u32 m0, m0, 1024
    s_add_u32 s31, s31, 8192
    buffer_load_dwordx4 v3, s[8:11], s31 offen lds
    s_add_u32 m0, m0, 1024
    s_add_u32 s31, s31, 8192
    buffer_load_dwordx4 v3, s[8:11], s31 offen lds
    s_add_u32 m0, m0, 1024
    s_add_u32 s31, s31, 8192
    buffer_load_dwordx4 v3, s[8:11], s31 offen lds
    s_add_u32 m0, m0, 1024
    s_add_u32 s31, s31, 8192
    buffer_load_dwordx4 v3, s[8:11], s31 offen lds
    s_add_u32 s26, s26, 262144
    buffer_load_dwordx4 v[80:83], v4, s[12:15], s23 offen offset:0
    buffer_load_dwordx4 v[84:87], v4, s[12:15], s23 offen offset:1024
    buffer_load_dwordx4 v[88:91], v4, s[12:15], s23 offen offset:2048
    buffer_load_dwordx4 v[92:95], v4, s[12:15], s23 offen offset:3072
    s_add_u32 s23, s23, 4096
    buffer_load_dwordx4 v[96:99], v4, s[12:15], s23 offen offset:0
    buffer_load_dwordx4 v[100:103], v4, s[12:15], s23 offen offset:1024
    buffer_load_dwordx4 v[104:107], v4, s[12:15], s23 offen offset:2048
    buffer_load_dwordx4 v[108:111], v4, s[12:15], s23 offen offset:3072
    s_add_u32 s23, s23, 4096
    buffer_load_dwordx4 v[112:115], v4, s[12:15], s23 offen offset:0
    buffer_load_dwordx4 v[116:119], v4, s[12:15], s23 offen offset:1024
    buffer_load_dwordx4 v[120:123], v4, s[12:15], s23 offen offset:2048
    buffer_load_dwordx4 v[124:127], v4, s[12:15], s23 offen offset:3072
    s_add_u32 s23, s23, 4096
    buffer_load_dwordx4 v[128:131], v4, s[12:15], s23 offen offset:0
    buffer_load_dwordx4 v[132:135], v4, s[12:15], s23 offen offset:1024
    buffer_load_dwordx4 v[136:139], v4, s[12:15], s23 offen offset:2048
    buffer_load_dwordx4 v[140:143], v4, s[12:15], s23 offen offset:3072
    s_add_u32 s23, s23, 4096
    s_mov_b32 s27, 0
    s_waitcnt vmcnt(0)
    s_barrier
oproj_loop:
    s_add_u32 s30, s27, 1
    s_cmp_ge_u32 s30, s22
    s_cbranch_scc1 oproj_nodma0
    s_lshl_b32 s30, s16, 13
    s_add_u32 s30, s30, 32768
    s_mov_b32 m0, s30
    s_mov_b32 s31, s26
    buffer_load_dwordx4 v3, s[8:11], s31 offen lds
    s_add_u32 m0, m0, 1024
    s_add_u32 s31, s31, 8192
    buffer_load_dwordx4 v3, s[8:11], s31 offen lds
    s_add_u32 m0, m0, 1024
    s_add_u32 s31, s31, 8192
    buffer_load_dwordx4 v3, s[8:11], s31 offen lds
    s_add_u32 m0, m0, 1024
    s_add_u32 s31, s31, 8192
    buffer_load_dwordx4 v3, s[8:11], s31 offen lds
    s_add_u32 m0, m0, 1024
    s_add_u32 s31, s31, 8192
    buffer_load_dwordx4 v3, s[8:11], s31 offen lds
    s_add_u32 m0, m0, 1024
    s_add_u32 s31, s31, 8192
    buffer_load_dwordx4 v3, s[8:11], s31 offen lds
    s_add_u32 m0, m0, 1024
    s_add_u32 s31, s31, 8192
    buffer_load_dwordx4 v3, s[8:11], s31 offen lds
    s_add_u32 m0, m0, 1024
    s_add_u32 s31, s31, 8192
    buffer_load_dwordx4 v3, s[8:11], s31 offen lds
    s_add_u32 s26, s26, 262144
    buffer_load_dwordx4 v[144:147], v4, s[12:15], s23 offen offset:0
    buffer_load_dwordx4 v[148:151], v4, s[12:15], s23 offen offset:1024
    buffer_load_dwordx4 v[152:155], v4, s[12:15], s23 offen offset:2048
    buffer_load_dwordx4 v[156:159], v4, s[12:15], s23 offen offset:3072
    s_add_u32 s23, s23, 4096
    buffer_load_dwordx4 v[160:163], v4, s[12:15], s23 offen offset:0
    buffer_load_dwordx4 v[164:167], v4, s[12:15], s23 offen offset:1024
    buffer_load_dwordx4 v[168:171], v4, s[12:15], s23 offen offset:2048
    buffer_load_dwordx4 v[172:175], v4, s[12:15], s23 offen offset:3072
    s_add_u32 s23, s23, 4096
    buffer_load_dwordx4 v[176:179], v4, s[12:15], s23 offen offset:0
    buffer_load_dwordx4 v[180:183], v4, s[12:15], s23 offen offset:1024
    buffer_load_dwordx4 v[184:187], v4, s[12:15], s23 offen offset:2048
    buffer_load_dwordx4 v[188:191], v4, s[12:15], s23 offen offset:3072
    s_add_u32 s23, s23, 4096
    buffer_load_dwordx4 v[192:195], v4, s[12:15], s23 offen offset:0
    buffer_load_dwordx4 v[196:199], v4, s[12:15], s23 offen offset:1024
    buffer_load_dwordx4 v[200:203], v4, s[12:15], s23 offen offset:2048
    buffer_load_dwordx4 v[204:207], v4, s[12:15], s23 offen offset:3072
    s_add_u32 s23, s23, 4096
oproj_nodma0:
    ds_read_b64_tr_b16 v[64:65], v2 offset:0
    ds_read_b64_tr_b16 v[66:67], v2 offset:1024
    ds_read_b64_tr_b16 v[68:69], v2 offset:2048
    ds_read_b64_tr_b16 v[70:71], v2 offset:3072
    ds_read_b64_tr_b16 v[72:73], v2 offset:4096
    ds_read_b64_tr_b16 v[74:75], v2 offset:5120
    ds_read_b64_tr_b16 v[76:77], v2 offset:6144
    ds_read_b64_tr_b16 v[78:79], v2 offset:7168
    s_waitcnt lgkmcnt(6)
    v_mfma_f32_32x32x16_bf16 v[48:63], v[64:67], v[80:83], v[48:63]
    ds_read_b64_tr_b16 v[64:65], v2 offset:8192
    ds_read_b64_tr_b16 v[66:67], v2 offset:9216
    s_waitcnt lgkmcnt(6)
    v_mfma_f32_32x32x16_bf16 v[48:63], v[68:71], v[84:87], v[48:63]
    ds_read_b64_tr_b16 v[68:69], v2 offset:10240
    ds_read_b64_tr_b16 v[70:71], v2 offset:11264
    s_waitcnt lgkmcnt(6)
    v_mfma_f32_32x32x16_bf16 v[48:63], v[72:75], v[88:91], v[48:63]
    ds_read_b64_tr_b16 v[72:73], v2 offset:12288
    ds_read_b64_tr_b16 v[74:75], v2 offset:13312
    s_waitcnt lgkmcnt(6)
    v_mfma_f32_32x32x16_bf16 v[48:63], v[76:79], v[92:95], v[48:63]
    ds_read_b64_tr_b16 v[76:77], v2 offset:14336
    ds_read_b64_tr_b16 v[78:79], v2 offset:15360
    s_waitcnt lgkmcnt(6)
    v_mfma_f32_32x32x16_bf16 v[48:63], v[64:67], v[96:99], v[48:63]
    ds_read_b64_tr_b16 v[64:65], v2 offset:16384
    ds_read_b64_tr_b16 v[66:67], v2 offset:17408
    s_waitcnt lgkmcnt(6)
    v_mfma_f32_32x32x16_bf16 v[48:63], v[68:71], v[100:103], v[48:63]
    ds_read_b64_tr_b16 v[68:69], v2 offset:18432
    ds_read_b64_tr_b16 v[70:71], v2 offset:19456
    s_waitcnt lgkmcnt(6)
    v_mfma_f32_32x32x16_bf16 v[48:63], v[72:75], v[104:107], v[48:63]
    ds_read_b64_tr_b16 v[72:73], v2 offset:20480
    ds_read_b64_tr_b16 v[74:75], v2 offset:21504
    s_waitcnt lgkmcnt(6)
    v_mfma_f32_32x32x16_bf16 v[48:63], v[76:79], v[108:111], v[48:63]
    ds_read_b64_tr_b16 v[76:77], v2 offset:22528
    ds_read_b64_tr_b16 v[78:79], v2 offset:23552
    s_waitcnt lgkmcnt(6)
    v_mfma_f32_32x32x16_bf16 v[48:63], v[64:67], v[112:115], v[48:63]
    ds_read_b64_tr_b16 v[64:65], v2 offset:24576
    ds_read_b64_tr_b16 v[66:67], v2 offset:25600
    s_waitcnt lgkmcnt(6)
    v_mfma_f32_32x32x16_bf16 v[48:63], v[68:71], v[116:119], v[48:63]
    ds_read_b64_tr_b16 v[68:69], v2 offset:26624
    ds_read_b64_tr_b16 v[70:71], v2 offset:27648
    s_waitcnt lgkmcnt(6)
    v_mfma_f32_32x32x16_bf16 v[48:63], v[72:75], v[120:123], v[48:63]
    ds_read_b64_tr_b16 v[72:73], v2 offset:28672
    ds_read_b64_tr_b16 v[74:75], v2 offset:29696
    s_waitcnt lgkmcnt(6)
    v_mfma_f32_32x32x16_bf16 v[48:63], v[76:79], v[124:127], v[48:63]
    ds_read_b64_tr_b16 v[76:77], v2 offset:30720
    ds_read_b64_tr_b16 v[78:79], v2 offset:31744
    s_waitcnt lgkmcnt(6)
    v_mfma_f32_32x32x16_bf16 v[48:63], v[64:67], v[128:131], v[48:63]
    s_waitcnt lgkmcnt(4)
    v_mfma_f32_32x32x16_bf16 v[48:63], v[68:71], v[132:135], v[48:63]
    s_waitcnt lgkmcnt(2)
    v_mfma_f32_32x32x16_bf16 v[48:63], v[72:75], v[136:139], v[48:63]
    s_waitcnt lgkmcnt(0)
    v_mfma_f32_32x32x16_bf16 v[48:63], v[76:79], v[140:143], v[48:63]
    s_waitcnt vmcnt(0)
    s_barrier
    s_add_u32 s27, s27, 1
    s_add_u32 s30, s27, 1
    s_cmp_ge_u32 s30, s22
    s_cbranch_scc1 oproj_nodma1
    s_lshl_b32 s30, s16, 13
    s_add_u32 s30, s30, 0
    s_mov_b32 m0, s30
    s_mov_b32 s31, s26
    buffer_load_dwordx4 v3, s[8:11], s31 offen lds
    s_add_u32 m0, m0, 1024
    s_add_u32 s31, s31, 8192
    buffer_load_dwordx4 v3, s[8:11], s31 offen lds
    s_add_u32 m0, m0, 1024
    s_add_u32 s31, s31, 8192
    buffer_load_dwordx4 v3, s[8:11], s31 offen lds
    s_add_u32 m0, m0, 1024
    s_add_u32 s31, s31, 8192
    buffer_load_dwordx4 v3, s[8:11], s31 offen lds
    s_add_u32 m0, m0, 1024
    s_add_u32 s31, s31, 8192
    buffer_load_dwordx4 v3, s[8:11], s31 offen lds
    s_add_u32 m0, m0, 1024
    s_add_u32 s31, s31, 8192
    buffer_load_dwordx4 v3, s[8:11], s31 offen lds
    s_add_u32 m0, m0, 1024
    s_add_u32 s31, s31, 8192
    buffer_load_dwordx4 v3, s[8:11], s31 offen lds
    s_add_u32 m0, m0, 1024
    s_add_u32 s31, s31, 8192
    buffer_load_dwordx4 v3, s[8:11], s31 offen lds
    s_add_u32 s26, s26, 262144
    buffer_load_dwordx4 v[80:83], v4, s[12:15], s23 offen offset:0
    buffer_load_dwordx4 v[84:87], v4, s[12:15], s23 offen offset:1024
    buffer_load_dwordx4 v[88:91], v4, s[12:15], s23 offen offset:2048
    buffer_load_dwordx4 v[92:95], v4, s[12:15], s23 offen offset:3072
    s_add_u32 s23, s23, 4096
    buffer_load_dwordx4 v[96:99], v4, s[12:15], s23 offen offset:0
    buffer_load_dwordx4 v[100:103], v4, s[12:15], s23 offen offset:1024
    buffer_load_dwordx4 v[104:107], v4, s[12:15], s23 offen offset:2048
    buffer_load_dwordx4 v[108:111], v4, s[12:15], s23 offen offset:3072
    s_add_u32 s23, s23, 4096
    buffer_load_dwordx4 v[112:115], v4, s[12:15], s23 offen offset:0
    buffer_load_dwordx4 v[116:119], v4, s[12:15], s23 offen offset:1024
    buffer_load_dwordx4 v[120:123], v4, s[12:15], s23 offen offset:2048
    buffer_load_dwordx4 v[124:127], v4, s[12:15], s23 offen offset:3072
    s_add_u32 s23, s23, 4096
    buffer_load_dwordx4 v[128:131], v4, s[12:15], s23 offen offset:0
    buffer_load_dwordx4 v[132:135], v4, s[12:15], s23 offen offset:1024
    buffer_load_dwordx4 v[136:139], v4, s[12:15], s23 offen offset:2048
    buffer_load_dwordx4 v[140:143], v4, s[12:15], s23 offen offset:3072
    s_add_u32 s23, s23, 4096
oproj_nodma1:
    ds_read_b64_tr_b16 v[64:65], v2 offset:32768
    ds_read_b64_tr_b16 v[66:67], v2 offset:33792
    ds_read_b64_tr_b16 v[68:69], v2 offset:34816
    ds_read_b64_tr_b16 v[70:71], v2 offset:35840
    ds_read_b64_tr_b16 v[72:73], v2 offset:36864
    ds_read_b64_tr_b16 v[74:75], v2 offset:37888
    ds_read_b64_tr_b16 v[76:77], v2 offset:38912
    ds_read_b64_tr_b16 v[78:79], v2 offset:39936
    s_waitcnt lgkmcnt(6)
    v_mfma_f32_32x32x16_bf16 v[48:63], v[64:67], v[144:147], v[48:63]
    ds_read_b64_tr_b16 v[64:65], v2 offset:40960
    ds_read_b64_tr_b16 v[66:67], v2 offset:41984
    s_waitcnt lgkmcnt(6)
    v_mfma_f32_32x32x16_bf16 v[48:63], v[68:71], v[148:151], v[48:63]
    ds_read_b64_tr_b16 v[68:69], v2 offset:43008
    ds_read_b64_tr_b16 v[70:71], v2 offset:44032
    s_waitcnt lgkmcnt(6)
    v_mfma_f32_32x32x16_bf16 v[48:63], v[72:75], v[152:155], v[48:63]
    ds_read_b64_tr_b16 v[72:73], v2 offset:45056
    ds_read_b64_tr_b16 v[74:75], v2 offset:46080
    s_waitcnt lgkmcnt(6)
    v_mfma_f32_32x32x16_bf16 v[48:63], v[76:79], v[156:159], v[48:63]
    ds_read_b64_tr_b16 v[76:77], v2 offset:47104
    ds_read_b64_tr_b16 v[78:79], v2 offset:48128
    s_waitcnt lgkmcnt(6)
    v_mfma_f32_32x32x16_bf16 v[48:63], v[64:67], v[160:163], v[48:63]
    ds_read_b64_tr_b16 v[64:65], v2 offset:49152
    ds_read_b64_tr_b16 v[66:67], v2 offset:50176
    s_waitcnt lgkmcnt(6)
    v_mfma_f32_32x32x16_bf16 v[48:63], v[68:71], v[164:167], v[48:63]
    ds_read_b64_tr_b16 v[68:69], v2 offset:51200
    ds_read_b64_tr_b16 v[70:71], v2 offset:52224
    s_waitcnt lgkmcnt(6)
    v_mfma_f32_32x32x16_bf16 v[48:63], v[72:75], v[168:171], v[48:63]
    ds_read_b64_tr_b16 v[72:73], v2 offset:53248
    ds_read_b64_tr_b16 v[74:75], v2 offset:54272
    s_waitcnt lgkmcnt(6)
    v_mfma_f32_32x32x16_bf16 v[48:63], v[76:79], v[172:175], v[48:63]
    ds_read_b64_tr_b16 v[76:77], v2 offset:55296
    ds_read_b64_tr_b16 v[78:79], v2 offset:56320
    s_waitcnt lgkmcnt(6)
    v_mfma_f32_32x32x16_bf16 v[48:63], v[64:67], v[176:179], v[48:63]
    ds_read_b64_tr_b16 v[64:65], v2 offset:57344
    ds_read_b64_tr_b16 v[66:67], v2 offset:58368
    s_waitcnt lgkmcnt(6)
    v_mfma_f32_32x32x16_bf16 v[48:63], v[68:71], v[180:183], v[48:63]
    ds_read_b64_tr_b16 v[68:69], v2 offset:59392
    ds_read_b64_tr_b16 v[70:71], v2 offset:60416
    s_waitcnt lgkmcnt(6)
    v_mfma_f32_32x32x16_bf16 v[48:63], v[72:75], v[184:187], v[48:63]
    ds_read_b64_tr_b16 v[72:73], v2 offset:61440
    ds_read_b64_tr_b16 v[74:75], v2 offset:62464
    s_waitcnt lgkmcnt(6)
    v_mfma_f32_32x32x16_bf16 v[48:63], v[76:79], v[188:191], v[48:63]
    ds_read_b64_tr_b16 v[76:77], v2 offset:63488
    ds_read_b64_tr_b16 v[78:79], v2 offset:64512
    s_waitcnt lgkmcnt(6)
    v_mfma_f32_32x32x16_bf16 v[48:63], v[64:67], v[192:195], v[48:63]
    s_waitcnt lgkmcnt(4)
    v_mfma_f32_32x32x16_bf16 v[48:63], v[68:71], v[196:199], v[48:63]
    s_waitcnt lgkmcnt(2)
    v_mfma_f32_32x32x16_bf16 v[48:63], v[72:75], v[200:203], v[48:63]
    s_waitcnt lgkmcnt(0)
    v_mfma_f32_32x32x16_bf16 v[48:63], v[76:79], v[204:207], v[48:63]
    s_waitcnt vmcnt(0)
    s_barrier
    s_add_u32 s27, s27, 1
    s_cmp_lt_u32 s27, s22
    s_cbranch_scc1 oproj_loop
    s_nop 15
    v_and_b32 v5, 31, v0
    v_lshlrev_b32 v5, 11, v5
    v_lshl_add_u32 v5, v12, 3, v5
    s_lshl_b32 s30, s21, 1
    s_add_u32 s30, s30, s18
    s_lshl_b32 s30, s30, 16
    s_add_u32 s30, s30, s25
    s_lshl_b32 s31, s20, 7
    s_add_u32 s30, s30, s31
    s_lshl_b32 s31, s17, 6
    s_add_u32 s30, s30, s31
    v_cvt_pk_bf16_f32 v64, v48, v49
    v_cvt_pk_bf16_f32 v65, v50, v51
    v_cvt_pk_bf16_f32 v66, v52, v53
    v_cvt_pk_bf16_f32 v67, v54, v55
    v_cvt_pk_bf16_f32 v68, v56, v57
    v_cvt_pk_bf16_f32 v69, v58, v59
    v_cvt_pk_bf16_f32 v70, v60, v61
    v_cvt_pk_bf16_f32 v71, v62, v63
    buffer_store_dwordx2 v[64:65], v5, s[64:67], s30 offen offset:0
    buffer_store_dwordx2 v[66:67], v5, s[64:67], s30 offen offset:16
    buffer_store_dwordx2 v[68:69], v5, s[64:67], s30 offen offset:32
    buffer_store_dwordx2 v[70:71], v5, s[64:67], s30 offen offset:48
oproj_exit:
    s_endpgm
.section .rodata,"a"
.p2align 6
.amdhsa_kernel oproj_kernel
  .amdhsa_next_free_vgpr 208
  .amdhsa_next_free_sgpr 102
  .amdhsa_accum_offset 208
  .amdhsa_group_segment_fixed_size 0
  .amdhsa_kernarg_size 112
  .amdhsa_user_sgpr_count 2
  .amdhsa_user_sgpr_kernarg_segment_ptr 1
  .amdhsa_system_sgpr_workgroup_id_x 1
.end_amdhsa_kernel
.text
```
